```python
import torch

def _softmax(x, axis=-1):
    return torch.softmax(x, dim=axis)
def _gelu(x):
    return torch.nn.functional.gelu(x, approximate="tanh")
def _silu(x):
    return torch.nn.functional.silu(x)
def _sigmoid(x):
    return torch.sigmoid(x)
def _layernorm(x, axis=-1, eps=1e-5):
    m = x.mean(dim=axis, keepdim=True)
    v = x.var(dim=axis, keepdim=True, unbiased=False)
    return (x - m) / torch.sqrt(v + eps)
def _scatter_add(tgt, idx, src, axis=0):
    return tgt.clone().index_add_(axis, idx, src)
def _segment_sum(src, seg, n):
    out = torch.zeros((n,) + src.shape[1:], dtype=src.dtype)
    return out.index_add_(0, seg, src)
def _pad(x, pw):
    flat = tuple(v for pair in reversed(pw) for v in pair)
    return torch.nn.functional.pad(x, flat)

kernel_name = 'interleave_layers__sliding_block_cached__glu_gated_glu__decode'

def setup_inputs():

    _w = (lambda a: (lambda t: t.to(torch.bfloat16) if t.is_floating_point() else t)(torch.as_tensor(a)))
    def _A_setup():
        B, Sq, D = 4, 1, 512
        Hq, Hkv, Sk, Dh = 32, 8, 8192, 128
        assert Hq % Hkv == 0, (Hq, Hkv)
        return {
            "x": _w((lambda *s: torch.randn(*s, dtype=torch.bfloat16) * 0.05)(B, Sq, D)),
            "k_cache": _w((lambda *s: torch.randn(*s, dtype=torch.bfloat16) * 1.6)(B, Hkv, Sk, Dh)),
            "v_cache": _w((lambda *s: torch.randn(*s, dtype=torch.bfloat16) * 1.6)(B, Hkv, Sk, Dh)),
            "wq": _w((lambda *s: torch.randn(*s, dtype=torch.bfloat16) * 1.6)(D, Hq * Dh) * (D ** -0.5)),
            "wo": _w((lambda *s: torch.randn(*s, dtype=torch.bfloat16) * 1.6)(Hq * Dh, D) * ((Hq * Dh) ** -0.5)),
        }
    _A_in = _A_setup()

    def _B_setup():
        B, S, D, F = 4, 1, 512, 1792
        return {
            "x": _w((lambda *s: torch.randn(*s, dtype=torch.bfloat16) * 0.05)(B, S, D)),
            "w_gate": _w((lambda *s: torch.randn(*s, dtype=torch.bfloat16) * 0.05)(D, F)),
            "w_up": _w((lambda *s: torch.randn(*s, dtype=torch.bfloat16) * 0.05)(D, F)),
            "w_down": _w((lambda *s: torch.randn(*s, dtype=torch.bfloat16) * 0.05)(F, D)),
        }
    _B_in = _B_setup()

    return {
        "A_x": _A_in["x"],
        "A_k_cache": _A_in["k_cache"],
        "A_v_cache": _A_in["v_cache"],
        "A_wq": _A_in["wq"],
        "A_wo": _A_in["wo"],
        "B_x": _B_in["x"],
        "B_w_gate": _B_in["w_gate"],
        "B_w_up": _B_in["w_up"],
        "B_w_down": _B_in["w_down"],
    }

def reference(A_x, A_k_cache, A_v_cache, A_wq, A_wo, B_x, B_w_gate, B_w_up, B_w_down):
    def _A_ref(x, k_cache, v_cache, wq, wo):
        B, Sq, D = x.shape
        Hq, Dh = 32, 128
        Hkv, Sk = k_cache.shape[1], k_cache.shape[2]
        W = min(4096, max(256, Sk // 4))
        rep = Hq // Hkv
        q = (lambda x, *d: x.permute(*d))((x @ wq).reshape(B, Sq, Hq, Dh), 0, 2, 1, 3)
        k = (lambda x, n, axis: torch.repeat_interleave(x, n, dim=axis))(k_cache[:, :, Sk - W:, :], rep, axis=1)
        v = (lambda x, n, axis: torch.repeat_interleave(x, n, dim=axis))(v_cache[:, :, Sk - W:, :], rep, axis=1)
        scores = torch.einsum("bhqd,bhkd->bhqk", q, k) * (Dh ** -0.5)
        p = _softmax(scores, axis=-1)
        o = torch.einsum("bhqk,bhkd->bhqd", p, v)
        return (lambda x, *d: x.permute(*d))(o, 0, 2, 1, 3).reshape(B, Sq, Hq * Dh) @ wo

    def _B_ref(x, w_gate, w_up, w_down):
        g = torch.einsum("bsd,df->bsf", x, w_gate)
        u = torch.einsum("bsd,df->bsf", x, w_up)
        h = _sigmoid(g) * u
        return torch.einsum("bsf,fd->bsd", h, w_down)

    x = A_x
    x = x + _A_ref(_layernorm(x, axis=-1), A_k_cache, A_v_cache, A_wq, A_wo)
    x = x + _B_ref(_layernorm(x, axis=-1), B_w_gate, B_w_up, B_w_down)
    x = x + _A_ref(_layernorm(x, axis=-1), A_k_cache, A_v_cache, A_wq, A_wo)
    x = x + _B_ref(_layernorm(x, axis=-1), B_w_gate, B_w_up, B_w_down)
    return x
```

```asm
; @launch grid=(256,1,1) block=(512,1,1) lds=163840
.amdgcn_target "amdgcn-amd-amdhsa--gfx950"
.text
.globl interleave_layers__sliding_block_cached__glu_gated_glu__decode_kernel
.p2align 8
.type interleave_layers__sliding_block_cached__glu_gated_glu__decode_kernel,@function
interleave_layers__sliding_block_cached__glu_gated_glu__decode_kernel:
    s_cmp_ge_u32 s2, 256
    s_cbranch_scc1 L_end
    s_load_dwordx16 s[4:19], s[0:1], 0
    s_load_dwordx8 s[20:27], s[0:1], 64
    v_lshlrev_b32 v3, 2, v0
    v_and_b32 v3, 0xfc, v3
    v_add_u32 v3, 0x27c40, v3
    v_mov_b32 v4, 0
    ds_write_b32 v3, v4
    v_lshrrev_b32 v1, 6, v0
    v_and_b32 v0, 63, v0
    s_and_b32 s29, s2, 7
    v_readfirstlane_b32 s28, v1
    s_lshr_b32 s30, s2, 3
    s_and_b32 s31, s30, 3
    s_lshr_b32 s30, s30, 2
    s_getreg_b32 s33, hwreg(HW_REG_XCC_ID, 0, 4)
    s_and_b32 s32, s28, 3
    s_lshl_b32 s63, s31, 3
    s_add_u32 s63, s63, s29
    s_mov_b32 s35, 0
    s_mov_b32 s57, 0
    s_mov_b32 s62, 0x10000
    s_mov_b32 s96, 1
    s_add_u32 s97, s31, s29
    s_and_b32 s97, s97, 3
    s_cmp_lg_u32 s28, 0
    s_cbranch_scc1 Lnopf_1
    s_getpc_b64 s[98:99]
L_pc:
    s_sub_u32 s98, s98, L_pc-interleave_layers__sliding_block_cached__glu_gated_glu__decode_kernel
    s_subb_u32 s99, s99, 0
    v_lshlrev_b32 v3, 7, v0
    v_cmp_gt_u32 vcc, L_end-interleave_layers__sliding_block_cached__glu_gated_glu__decode_kernel, v3
    s_and_saveexec_b64 s[58:59], vcc
    s_cbranch_execz L_pf0
    global_load_dword v60, v3, s[98:99]
L_pf0:
    s_mov_b64 exec, s[58:59]
    v_add_u32 v3, 0x2000, v3
    v_cmp_gt_u32 vcc, L_end-interleave_layers__sliding_block_cached__glu_gated_glu__decode_kernel, v3
    s_and_saveexec_b64 s[58:59], vcc
    s_cbranch_execz L_pf1
    global_load_dword v61, v3, s[98:99]
L_pf1:
    s_mov_b64 exec, s[58:59]
    v_add_u32 v3, 0x2000, v3
Lnopf_1:
    s_lshl_b32 s58, s31, 7
    v_and_b32 v1, 15, v0
    v_lshrrev_b32 v2, 4, v0
    s_waitcnt lgkmcnt(0)
    s_load_dword s34, s[26:27], s58
    s_mov_b32 s48, s26
    s_mov_b32 s49, s27
    s_mov_b32 s50, 0x110000
    s_mov_b32 s51, 0x20000
    s_barrier
    s_cmp_ge_u32 s28, 4
    s_cbranch_scc1 L_W
    s_setprio 2
    s_lshl_b32 s58, s63, 21
    s_lshl_b32 s59, s30, 16
    s_add_u32 s58, s58, s59
    s_add_u32 s58, s58, 0x180000
    s_add_u32 s36, s6, s58
    s_addc_u32 s37, s7, 0
    s_mov_b32 s38, 0x10000
    s_mov_b32 s39, 0x20000
    s_add_u32 s40, s8, s58
    s_addc_u32 s41, s9, 0
    s_mov_b32 s42, 0x10000
    s_mov_b32 s43, 0x20000
    v_and_b32 v16, 7, v0
    v_lshlrev_b32 v16, 8, v16
    v_bfe_u32 v17, v0, 3, 1
    v_lshl_add_u32 v17, v17, 2, v2
    v_lshl_add_u32 v16, v17, 4, v16
    s_lshl_b32 s60, s32, 14
    s_add_u32 s58, s97, 0
    s_and_b32 s58, s58, 3
    s_lshl_b32 s58, s58, 12
    s_add_u32 s58, s58, s60
    buffer_load_dwordx4 v[64:67], v16, s[36:39], s58 offen offset:0 nt
    s_waitcnt vmcnt(3)
    buffer_load_dwordx4 v[68:71], v16, s[36:39], s58 offen offset:2048 nt
    s_waitcnt vmcnt(3)
    buffer_load_dwordx4 v[72:75], v16, s[36:39], s58 offen offset:128 nt
    s_waitcnt vmcnt(3)
    buffer_load_dwordx4 v[76:79], v16, s[36:39], s58 offen offset:2176 nt
    s_waitcnt vmcnt(3)
    s_add_u32 s58, s97, 1
    s_and_b32 s58, s58, 3
    s_lshl_b32 s58, s58, 12
    s_add_u32 s58, s58, s60
    buffer_load_dwordx4 v[80:83], v16, s[36:39], s58 offen offset:0 nt
    s_waitcnt vmcnt(3)
    buffer_load_dwordx4 v[84:87], v16, s[36:39], s58 offen offset:2048 nt
    s_waitcnt vmcnt(3)
    buffer_load_dwordx4 v[88:91], v16, s[36:39], s58 offen offset:128 nt
    s_waitcnt vmcnt(3)
    buffer_load_dwordx4 v[92:95], v16, s[36:39], s58 offen offset:2176 nt
    s_waitcnt vmcnt(3)
    s_add_u32 s58, s97, 2
    s_and_b32 s58, s58, 3
    s_lshl_b32 s58, s58, 12
    s_add_u32 s58, s58, s60
    buffer_load_dwordx4 v[96:99], v16, s[36:39], s58 offen offset:0 nt
    s_waitcnt vmcnt(3)
    buffer_load_dwordx4 v[100:103], v16, s[36:39], s58 offen offset:2048 nt
    s_waitcnt vmcnt(3)
    buffer_load_dwordx4 v[104:107], v16, s[36:39], s58 offen offset:128 nt
    s_waitcnt vmcnt(3)
    buffer_load_dwordx4 v[108:111], v16, s[36:39], s58 offen offset:2176 nt
    s_waitcnt vmcnt(3)
    s_add_u32 s58, s97, 3
    s_and_b32 s58, s58, 3
    s_lshl_b32 s58, s58, 12
    s_add_u32 s58, s58, s60
    buffer_load_dwordx4 v[112:115], v16, s[36:39], s58 offen offset:0 nt
    s_waitcnt vmcnt(3)
    buffer_load_dwordx4 v[116:119], v16, s[36:39], s58 offen offset:2048 nt
    s_waitcnt vmcnt(3)
    buffer_load_dwordx4 v[120:123], v16, s[36:39], s58 offen offset:128 nt
    s_waitcnt vmcnt(3)
    buffer_load_dwordx4 v[124:127], v16, s[36:39], s58 offen offset:2176 nt
    s_waitcnt vmcnt(3)
    s_lshl_b32 s58, s32, 2
    s_add_u32 s58, s58, 0x27c40
    v_mov_b32 v3, s58
    v_mov_b32 v4, 0x27c40
    v_and_b32 v5, 3, v0
    v_lshlrev_b32 v6, 4, v5
    v_lshl_add_u32 v6, v2, 6, v6
    v_lshrrev_b32 v16, 2, v1
    v_add_u32 v16, s97, v16
    v_and_b32 v16, 3, v16
    v_lshlrev_b32 v16, 5, v16
    s_lshl_b32 s58, s32, 7
    v_lshl_add_u32 v16, v2, 3, v16
    v_add_u32 v16, s58, v16
    v_lshlrev_b32 v17, 6, v5
    v_xor_b32 v16, v16, v17
    v_lshlrev_b32 v18, 9, v5
    v_add_u32 v18, 0x20000, v18
    v_add_u32 v7, v16, v18
    v_xor_b32 v16, 0, v5
    v_lshlrev_b32 v16, 6, v16
    v_lshl_add_u32 v16, v2, 4, v16
    v_add_u32 v8, v16, v18
    v_xor_b32 v16, 1, v5
    v_lshlrev_b32 v16, 6, v16
    v_lshl_add_u32 v16, v2, 4, v16
    v_add_u32 v9, v16, v18
    v_xor_b32 v16, 2, v5
    v_lshlrev_b32 v16, 6, v16
    v_lshl_add_u32 v16, v2, 4, v16
    v_add_u32 v10, v16, v18
    v_xor_b32 v16, 3, v5
    v_lshlrev_b32 v16, 6, v16
    v_lshl_add_u32 v16, v2, 4, v16
    v_add_u32 v11, v16, v18
    v_lshlrev_b32 v12, 5, v5
    v_add_u32 v12, 0x20800, v12
    v_lshlrev_b32 v13, 11, v5
    v_lshrrev_b32 v16, 1, v2
    v_lshl_add_u32 v13, v16, 7, v13
    v_and_b32 v16, 1, v2
    v_lshl_add_u32 v13, v16, 3, v13
    v_lshlrev_b32 v14, 4, v1
    v_lshl_add_u32 v14, v2, 7, v14
    s_lshl_b32 s58, s32, 5
    s_add_u32 s58, s58, 0x27d40
    v_lshlrev_b32 v15, 1, v0
    v_add_u32 v15, s58, v15
    s_lshl_b32 s4, s63, 10
    s_add_u32 s4, s4, 0x10000
    s_lshl_b32 s58, s63, 13
    s_lshl_b32 s59, s30, 4
    s_add_u32 s58, s58, s59
    s_lshl_b32 s59, s32, 9
    s_add_u32 s58, s58, s59
    s_add_u32 s5, s58, 0x30000
    s_lshl_b32 s58, s63, 8
    s_lshl_b32 s59, s30, 2
    s_add_u32 s58, s58, s59
    s_add_u32 s10, s58, 0x2c000
    s_lshl_b32 s11, s63, 9
    s_add_u32 s11, s11, 0x28000
    s_lshl_b32 s58, s31, 13
    s_lshl_b32 s59, s29, 10
    s_add_u32 s58, s58, s59
    s_lshl_b32 s59, s30, 7
    s_add_u32 s58, s58, s59
    s_add_u32 s12, s58, 0x20000
    s_mov_b32 s14, 0xff00ff00
    s_mov_b32 s15, 0xff00ff00
    s_mov_b32 s6, 0x0f0f0f0f
    s_mov_b32 s7, 0x0f0f0f0f
    v_lshrrev_b32 v20, 1, v1
    v_xor_b32 v20, v20, v2
    v_lshlrev_b32 v20, 5, v20
    v_and_b32 v21, 1, v0
    v_lshl_add_u32 v20, v21, 4, v20
    v_lshl_add_u32 v20, v2, 8, v20
    v_xor_b32 v21, 0x80, v20
    s_lshl_b32 s61, s97, 2
    s_add_u32 s99, s61, 0
    s_and_b32 s99, s99, 15
    s_lshl_b32 s99, s99, 10
    s_add_u32 s99, s99, s60
    s_add_u32 s98, s99, 0x10000
    s_mov_b32 m0, s98
    s_nop 0
    buffer_load_dwordx4 v20, s[40:43], s99 offen nt lds
    s_waitcnt vmcnt(3)
    s_add_u32 s99, s61, 1
    s_and_b32 s99, s99, 15
    s_lshl_b32 s99, s99, 10
    s_add_u32 s99, s99, s60
    s_add_u32 s98, s99, 0x10000
    s_mov_b32 m0, s98
    s_nop 0
    buffer_load_dwordx4 v20, s[40:43], s99 offen nt lds
    s_waitcnt vmcnt(3)
    s_add_u32 s99, s61, 2
    s_and_b32 s99, s99, 15
    s_lshl_b32 s99, s99, 10
    s_add_u32 s99, s99, s60
    s_add_u32 s98, s99, 0x10000
    s_mov_b32 m0, s98
    s_nop 0
    buffer_load_dwordx4 v21, s[40:43], s99 offen nt lds
    s_waitcnt vmcnt(3)
    s_add_u32 s99, s61, 3
    s_and_b32 s99, s99, 15
    s_lshl_b32 s99, s99, 10
    s_add_u32 s99, s99, s60
    s_add_u32 s98, s99, 0x10000
    s_mov_b32 m0, s98
    s_nop 0
    buffer_load_dwordx4 v21, s[40:43], s99 offen nt lds
    s_waitcnt vmcnt(3)
    s_add_u32 s99, s61, 4
    s_and_b32 s99, s99, 15
    s_lshl_b32 s99, s99, 10
    s_add_u32 s99, s99, s60
    s_add_u32 s98, s99, 0x10000
    s_mov_b32 m0, s98
    s_nop 0
    buffer_load_dwordx4 v20, s[40:43], s99 offen nt lds
    v_mov_b32 v16, v64
    v_mov_b32 v17, v65
    v_mov_b32 v18, v66
    v_mov_b32 v19, v67
    v_mov_b32_dpp v64, v68 row_ror:8 row_mask:0xf bank_mask:0xc
    v_mov_b32_dpp v65, v69 row_ror:8 row_mask:0xf bank_mask:0xc
    v_mov_b32_dpp v66, v70 row_ror:8 row_mask:0xf bank_mask:0xc
    v_mov_b32_dpp v67, v71 row_ror:8 row_mask:0xf bank_mask:0xc
    v_mov_b32_dpp v68, v16 row_ror:8 row_mask:0xf bank_mask:0x3
    v_mov_b32_dpp v69, v17 row_ror:8 row_mask:0xf bank_mask:0x3
    v_mov_b32_dpp v70, v18 row_ror:8 row_mask:0xf bank_mask:0x3
    v_mov_b32_dpp v71, v19 row_ror:8 row_mask:0xf bank_mask:0x3
    s_add_u32 s99, s61, 5
    s_and_b32 s99, s99, 15
    s_lshl_b32 s99, s99, 10
    s_add_u32 s99, s99, s60
    s_add_u32 s98, s99, 0x10000
    s_mov_b32 m0, s98
    s_nop 0
    buffer_load_dwordx4 v20, s[40:43], s99 offen nt lds
    v_mov_b32 v16, v72
    v_mov_b32 v17, v73
    v_mov_b32 v18, v74
    v_mov_b32 v19, v75
    v_mov_b32_dpp v72, v76 row_ror:8 row_mask:0xf bank_mask:0xc
    v_mov_b32_dpp v73, v77 row_ror:8 row_mask:0xf bank_mask:0xc
    v_mov_b32_dpp v74, v78 row_ror:8 row_mask:0xf bank_mask:0xc
    v_mov_b32_dpp v75, v79 row_ror:8 row_mask:0xf bank_mask:0xc
    v_mov_b32_dpp v76, v16 row_ror:8 row_mask:0xf bank_mask:0x3
    v_mov_b32_dpp v77, v17 row_ror:8 row_mask:0xf bank_mask:0x3
    v_mov_b32_dpp v78, v18 row_ror:8 row_mask:0xf bank_mask:0x3
    v_mov_b32_dpp v79, v19 row_ror:8 row_mask:0xf bank_mask:0x3
    s_add_u32 s99, s61, 6
    s_and_b32 s99, s99, 15
    s_lshl_b32 s99, s99, 10
    s_add_u32 s99, s99, s60
    s_add_u32 s98, s99, 0x10000
    s_mov_b32 m0, s98
    s_nop 0
    buffer_load_dwordx4 v21, s[40:43], s99 offen nt lds
    v_mov_b32 v16, v80
    v_mov_b32 v17, v81
    v_mov_b32 v18, v82
    v_mov_b32 v19, v83
    v_mov_b32_dpp v80, v84 row_ror:8 row_mask:0xf bank_mask:0xc
    v_mov_b32_dpp v81, v85 row_ror:8 row_mask:0xf bank_mask:0xc
    v_mov_b32_dpp v82, v86 row_ror:8 row_mask:0xf bank_mask:0xc
    v_mov_b32_dpp v83, v87 row_ror:8 row_mask:0xf bank_mask:0xc
    v_mov_b32_dpp v84, v16 row_ror:8 row_mask:0xf bank_mask:0x3
    v_mov_b32_dpp v85, v17 row_ror:8 row_mask:0xf bank_mask:0x3
    v_mov_b32_dpp v86, v18 row_ror:8 row_mask:0xf bank_mask:0x3
    v_mov_b32_dpp v87, v19 row_ror:8 row_mask:0xf bank_mask:0x3
    s_add_u32 s99, s61, 7
    s_and_b32 s99, s99, 15
    s_lshl_b32 s99, s99, 10
    s_add_u32 s99, s99, s60
    s_add_u32 s98, s99, 0x10000
    s_mov_b32 m0, s98
    s_nop 0
    buffer_load_dwordx4 v21, s[40:43], s99 offen nt lds
    v_mov_b32 v16, v88
    v_mov_b32 v17, v89
    v_mov_b32 v18, v90
    v_mov_b32 v19, v91
    v_mov_b32_dpp v88, v92 row_ror:8 row_mask:0xf bank_mask:0xc
    v_mov_b32_dpp v89, v93 row_ror:8 row_mask:0xf bank_mask:0xc
    v_mov_b32_dpp v90, v94 row_ror:8 row_mask:0xf bank_mask:0xc
    v_mov_b32_dpp v91, v95 row_ror:8 row_mask:0xf bank_mask:0xc
    v_mov_b32_dpp v92, v16 row_ror:8 row_mask:0xf bank_mask:0x3
    v_mov_b32_dpp v93, v17 row_ror:8 row_mask:0xf bank_mask:0x3
    v_mov_b32_dpp v94, v18 row_ror:8 row_mask:0xf bank_mask:0x3
    v_mov_b32_dpp v95, v19 row_ror:8 row_mask:0xf bank_mask:0x3
    s_add_u32 s99, s61, 8
    s_and_b32 s99, s99, 15
    s_lshl_b32 s99, s99, 10
    s_add_u32 s99, s99, s60
    s_add_u32 s98, s99, 0x10000
    s_mov_b32 m0, s98
    s_nop 0
    buffer_load_dwordx4 v20, s[40:43], s99 offen nt lds
    v_mov_b32 v16, v96
    v_mov_b32 v17, v97
    v_mov_b32 v18, v98
    v_mov_b32 v19, v99
    v_mov_b32_dpp v96, v100 row_ror:8 row_mask:0xf bank_mask:0xc
    v_mov_b32_dpp v97, v101 row_ror:8 row_mask:0xf bank_mask:0xc
    v_mov_b32_dpp v98, v102 row_ror:8 row_mask:0xf bank_mask:0xc
    v_mov_b32_dpp v99, v103 row_ror:8 row_mask:0xf bank_mask:0xc
    v_mov_b32_dpp v100, v16 row_ror:8 row_mask:0xf bank_mask:0x3
    v_mov_b32_dpp v101, v17 row_ror:8 row_mask:0xf bank_mask:0x3
    v_mov_b32_dpp v102, v18 row_ror:8 row_mask:0xf bank_mask:0x3
    v_mov_b32_dpp v103, v19 row_ror:8 row_mask:0xf bank_mask:0x3
    s_add_u32 s99, s61, 9
    s_and_b32 s99, s99, 15
    s_lshl_b32 s99, s99, 10
    s_add_u32 s99, s99, s60
    s_add_u32 s98, s99, 0x10000
    s_mov_b32 m0, s98
    s_nop 0
    buffer_load_dwordx4 v20, s[40:43], s99 offen nt lds
    v_mov_b32 v16, v104
    v_mov_b32 v17, v105
    v_mov_b32 v18, v106
    v_mov_b32 v19, v107
    v_mov_b32_dpp v104, v108 row_ror:8 row_mask:0xf bank_mask:0xc
    v_mov_b32_dpp v105, v109 row_ror:8 row_mask:0xf bank_mask:0xc
    v_mov_b32_dpp v106, v110 row_ror:8 row_mask:0xf bank_mask:0xc
    v_mov_b32_dpp v107, v111 row_ror:8 row_mask:0xf bank_mask:0xc
    v_mov_b32_dpp v108, v16 row_ror:8 row_mask:0xf bank_mask:0x3
    v_mov_b32_dpp v109, v17 row_ror:8 row_mask:0xf bank_mask:0x3
    v_mov_b32_dpp v110, v18 row_ror:8 row_mask:0xf bank_mask:0x3
    v_mov_b32_dpp v111, v19 row_ror:8 row_mask:0xf bank_mask:0x3
    s_add_u32 s99, s61, 10
    s_and_b32 s99, s99, 15
    s_lshl_b32 s99, s99, 10
    s_add_u32 s99, s99, s60
    s_add_u32 s98, s99, 0x10000
    s_mov_b32 m0, s98
    s_nop 0
    buffer_load_dwordx4 v21, s[40:43], s99 offen nt lds
    v_mov_b32 v16, v112
    v_mov_b32 v17, v113
    v_mov_b32 v18, v114
    v_mov_b32 v19, v115
    v_mov_b32_dpp v112, v116 row_ror:8 row_mask:0xf bank_mask:0xc
    v_mov_b32_dpp v113, v117 row_ror:8 row_mask:0xf bank_mask:0xc
    v_mov_b32_dpp v114, v118 row_ror:8 row_mask:0xf bank_mask:0xc
    v_mov_b32_dpp v115, v119 row_ror:8 row_mask:0xf bank_mask:0xc
    v_mov_b32_dpp v116, v16 row_ror:8 row_mask:0xf bank_mask:0x3
    v_mov_b32_dpp v117, v17 row_ror:8 row_mask:0xf bank_mask:0x3
    v_mov_b32_dpp v118, v18 row_ror:8 row_mask:0xf bank_mask:0x3
    v_mov_b32_dpp v119, v19 row_ror:8 row_mask:0xf bank_mask:0x3
    s_add_u32 s99, s61, 11
    s_and_b32 s99, s99, 15
    s_lshl_b32 s99, s99, 10
    s_add_u32 s99, s99, s60
    s_add_u32 s98, s99, 0x10000
    s_mov_b32 m0, s98
    s_nop 0
    buffer_load_dwordx4 v21, s[40:43], s99 offen nt lds
    v_mov_b32 v16, v120
    v_mov_b32 v17, v121
    v_mov_b32 v18, v122
    v_mov_b32 v19, v123
    v_mov_b32_dpp v120, v124 row_ror:8 row_mask:0xf bank_mask:0xc
    v_mov_b32_dpp v121, v125 row_ror:8 row_mask:0xf bank_mask:0xc
    v_mov_b32_dpp v122, v126 row_ror:8 row_mask:0xf bank_mask:0xc
    v_mov_b32_dpp v123, v127 row_ror:8 row_mask:0xf bank_mask:0xc
    v_mov_b32_dpp v124, v16 row_ror:8 row_mask:0xf bank_mask:0x3
    v_mov_b32_dpp v125, v17 row_ror:8 row_mask:0xf bank_mask:0x3
    v_mov_b32_dpp v126, v18 row_ror:8 row_mask:0xf bank_mask:0x3
    v_mov_b32_dpp v127, v19 row_ror:8 row_mask:0xf bank_mask:0x3
    s_add_u32 s99, s61, 12
    s_and_b32 s99, s99, 15
    s_lshl_b32 s99, s99, 10
    s_add_u32 s99, s99, s60
    s_add_u32 s98, s99, 0x10000
    s_mov_b32 m0, s98
    s_nop 0
    buffer_load_dwordx4 v20, s[40:43], s99 offen nt lds
    s_add_u32 s99, s61, 13
    s_and_b32 s99, s99, 15
    s_lshl_b32 s99, s99, 10
    s_add_u32 s99, s99, s60
    s_add_u32 s98, s99, 0x10000
    s_mov_b32 m0, s98
    s_nop 0
    buffer_load_dwordx4 v20, s[40:43], s99 offen nt lds
    s_add_u32 s99, s61, 14
    s_and_b32 s99, s99, 15
    s_lshl_b32 s99, s99, 10
    s_add_u32 s99, s99, s60
    s_add_u32 s98, s99, 0x10000
    s_mov_b32 m0, s98
    s_nop 0
    buffer_load_dwordx4 v21, s[40:43], s99 offen nt lds
    s_add_u32 s99, s61, 15
    s_and_b32 s99, s99, 15
    s_lshl_b32 s99, s99, 10
    s_add_u32 s99, s99, s60
    s_add_u32 s98, s99, 0x10000
    s_mov_b32 m0, s98
    s_nop 0
    buffer_load_dwordx4 v21, s[40:43], s99 offen nt lds
    v_mov_b32 v22, 1
    s_mov_b64 exec, 1
    ds_write_b32 v3, v22 offset:240
    s_mov_b64 exec, -1
    v_mov_b32 v16, 0
    v_mov_b32 v17, 0
    v_mov_b32 v18, 0
    v_mov_b32 v19, 0
    v_mov_b32 v20, 0
    v_mov_b32 v21, 0
    v_mov_b32 v22, 0
    v_mov_b32 v23, 0
    v_mov_b32 v24, 0
    v_mov_b32 v25, 0
    v_mov_b32 v26, 0
    v_mov_b32 v27, 0
    v_mov_b32 v28, 0
    v_mov_b32 v29, 0
    v_mov_b32 v30, 0
    v_mov_b32 v31, 0
    s_mov_b32 s56, 0
Lfw_qb_2:
    ds_read_b32 v32, v4 offset:48
    s_waitcnt lgkmcnt(0)
    v_cmp_le_u32 vcc, 1, v32
    s_cbranch_vccnz Lfd_qb_3
    s_add_u32 s56, s56, 1
    s_cmp_lt_u32 s56, 0x61a80
    s_cbranch_scc1 Lfw_qb_2
    s_branch L_abort
Lfd_qb_3:
    v_readfirstlane_b32 s58, v32
    v_add_u32 v33, 0x21000, v6
    s_mov_b64 exec, s[6:7]
    ds_read_b128 v[16:19], v33 offset:0
    ds_read_b128 v[20:23], v33 offset:256
    ds_read_b128 v[24:27], v33 offset:512
    ds_read_b128 v[28:31], v33 offset:768
    s_mov_b64 exec, -1
    s_lshr_b32 s57, s58, 1
    s_waitcnt lgkmcnt(0)
    s_branch L_A_qk
L_A_loop:
    v_mov_b32 v16, 0
    v_mov_b32 v17, 0
    v_mov_b32 v18, 0
    v_mov_b32 v19, 0
    v_mov_b32 v20, 0
    v_mov_b32 v21, 0
    v_mov_b32 v22, 0
    v_mov_b32 v23, 0
    v_mov_b32 v24, 0
    v_mov_b32 v25, 0
    v_mov_b32 v26, 0
    v_mov_b32 v27, 0
    v_mov_b32 v28, 0
    v_mov_b32 v29, 0
    v_mov_b32 v30, 0
    v_mov_b32 v31, 0
    s_barrier
    s_barrier
    s_mov_b64 exec, s[6:7]
    s_mov_b32 s56, 0
Lpoll_q_4:
    buffer_load_dwordx4 v[16:19], v6, s[48:51], s4 offen offset:0 sc1
    buffer_load_dwordx4 v[20:23], v6, s[48:51], s4 offen offset:256 sc1
    buffer_load_dwordx4 v[24:27], v6, s[48:51], s4 offen offset:512 sc1
    buffer_load_dwordx4 v[28:31], v6, s[48:51], s4 offen offset:768 sc1
    s_waitcnt vmcnt(0)
    v_max3_u32 v32, v16, v17, v18
    v_max3_u32 v32, v32, v19, v20
    v_max3_u32 v32, v32, v21, v22
    v_max3_u32 v32, v32, v23, v24
    v_max3_u32 v32, v32, v25, v26
    v_max3_u32 v32, v32, v27, v28
    v_max3_u32 v32, v32, v29, v30
    v_max_u32 v32, v32, v31
    v_cmp_eq_u32 vcc, -1, v32
    s_cbranch_vccnz Lretry_q_5
    s_mov_b64 exec, -1
L_A_qk:
    v_mov_b32_dpp v32, v16 row_ror:4 row_mask:0xf bank_mask:0xf
    v_mov_b32_dpp v33, v17 row_ror:4 row_mask:0xf bank_mask:0xf
    v_mov_b32_dpp v34, v18 row_ror:4 row_mask:0xf bank_mask:0xf
    v_mov_b32_dpp v35, v19 row_ror:4 row_mask:0xf bank_mask:0xf
    v_mfma_f32_16x16x32_bf16 v[48:51], v[64:67], v[16:19], 0
    v_mfma_f32_16x16x32_bf16 v[52:55], v[96:99], v[16:19], 0
    v_mov_b32_dpp v36, v20 row_ror:4 row_mask:0xf bank_mask:0xf
    v_mov_b32_dpp v37, v21 row_ror:4 row_mask:0xf bank_mask:0xf
    v_mov_b32_dpp v38, v22 row_ror:4 row_mask:0xf bank_mask:0xf
    v_mov_b32_dpp v39, v23 row_ror:4 row_mask:0xf bank_mask:0xf
    v_mfma_f32_16x16x32_bf16 v[48:51], v[80:83], v[32:35], v[48:51]
    v_mfma_f32_16x16x32_bf16 v[52:55], v[112:115], v[32:35], v[52:55]
    v_mfma_f32_16x16x32_bf16 v[48:51], v[68:71], v[20:23], v[48:51]
    v_mfma_f32_16x16x32_bf16 v[52:55], v[100:103], v[20:23], v[52:55]
    v_mov_b32_dpp v40, v24 row_ror:4 row_mask:0xf bank_mask:0xf
    v_mov_b32_dpp v41, v25 row_ror:4 row_mask:0xf bank_mask:0xf
    v_mov_b32_dpp v42, v26 row_ror:4 row_mask:0xf bank_mask:0xf
    v_mov_b32_dpp v43, v27 row_ror:4 row_mask:0xf bank_mask:0xf
    v_mfma_f32_16x16x32_bf16 v[48:51], v[84:87], v[36:39], v[48:51]
    v_mfma_f32_16x16x32_bf16 v[52:55], v[116:119], v[36:39], v[52:55]
    v_mfma_f32_16x16x32_bf16 v[48:51], v[72:75], v[24:27], v[48:51]
    v_mfma_f32_16x16x32_bf16 v[52:55], v[104:107], v[24:27], v[52:55]
    v_mov_b32_dpp v44, v28 row_ror:4 row_mask:0xf bank_mask:0xf
    v_mov_b32_dpp v45, v29 row_ror:4 row_mask:0xf bank_mask:0xf
    v_mov_b32_dpp v46, v30 row_ror:4 row_mask:0xf bank_mask:0xf
    v_mov_b32_dpp v47, v31 row_ror:4 row_mask:0xf bank_mask:0xf
    v_mfma_f32_16x16x32_bf16 v[48:51], v[88:91], v[40:43], v[48:51]
    v_mfma_f32_16x16x32_bf16 v[52:55], v[120:123], v[40:43], v[52:55]
    v_mfma_f32_16x16x32_bf16 v[48:51], v[76:79], v[28:31], v[48:51]
    v_mfma_f32_16x16x32_bf16 v[52:55], v[108:111], v[28:31], v[52:55]
    v_mfma_f32_16x16x32_bf16 v[48:51], v[92:95], v[44:47], v[48:51]
    v_mfma_f32_16x16x32_bf16 v[52:55], v[124:127], v[44:47], v[52:55]
    s_mov_b32 s100, 0x3e0293ee
    s_nop 6
    v_cndmask_b32 v48, v48, v52, s[14:15]
    v_cndmask_b32 v49, v49, v53, s[14:15]
    v_cndmask_b32 v50, v50, v54, s[14:15]
    v_cndmask_b32 v51, v51, v55, s[14:15]
    v_max3_f32 v56, v48, v49, v50
    v_max_f32 v56, v56, v51
    s_nop 1
    v_max_f32_dpp v56, v56, v56 row_ror:4 row_mask:0xf bank_mask:0xf
    s_nop 1
    v_max_f32_dpp v56, v56, v56 row_ror:8 row_mask:0xf bank_mask:0xf
    v_mov_b32 v57, v56
    s_nop 1
    v_permlane16_swap_b32 v57, v56
    v_max_f32 v56, v56, v57
    v_mov_b32 v57, v56
    s_nop 1
    v_permlane32_swap_b32 v57, v56
    v_max_f32 v56, v56, v57
    v_mul_f32 v56, s100, v56
    v_fma_f32 v48, v48, s100, -v56
    v_fma_f32 v49, v49, s100, -v56
    v_fma_f32 v50, v50, s100, -v56
    v_fma_f32 v51, v51, s100, -v56
    v_exp_f32 v48, v48
    v_exp_f32 v49, v49
    v_exp_f32 v50, v50
    v_exp_f32 v51, v51
    s_nop 0
    v_cvt_pk_bf16_f32 v52, v48, v49
    v_cvt_pk_bf16_f32 v53, v50, v51
    ds_write_b64 v7, v[52:53]
    v_add_f32 v57, v48, v49
    v_add_f32 v58, v50, v51
    v_add_f32 v57, v57, v58
    s_nop 1
    v_add_f32_dpp v57, v57, v57 row_ror:4 row_mask:0xf bank_mask:0xf
    s_nop 1
    v_add_f32_dpp v57, v57, v57 row_ror:8 row_mask:0xf bank_mask:0xf
    v_mov_b32 v58, v57
    s_nop 1
    v_permlane16_swap_b32 v58, v57
    v_add_f32 v57, v57, v58
    v_mov_b32 v58, v57
    s_nop 1
    v_permlane32_swap_b32 v58, v57
    v_add_f32 v57, v57, v58
    s_lshl_b32 s58, s32, 3
    v_add_u32 v58, s58, v12
    s_mov_b64 exec, 0xf
    ds_write_b64 v58, v[56:57]
    s_mov_b64 exec, -1
    s_cmp_eq_u32 s35, 0
    s_cbranch_scc1 Lg0_p_6
    s_waitcnt lgkmcnt(0)
    s_barrier
Lgd_p_7:
    ds_read_b128 v[16:19], v12
    ds_read_b128 v[20:23], v12 offset:16
    s_cmp_lg_u32 s35, 0
    s_cbranch_scc1 La2_10
    v_lshrrev_b32 v24, 2, v1
    v_lshl_add_u32 v25, v2, 3, v24
    v_lshlrev_b32 v25, 8, v25
    v_and_b32 v26, 1, v2
    v_lshl_or_b32 v24, v26, 2, v24
    v_lshl_add_u32 v25, v5, 3, v25
    v_add_u32 v25, 0x10000, v25
    s_lshl_b32 s58, s32, 1
    s_add_u32 s59, s58, 1
    v_xor_b32 v26, s58, v24
    v_lshl_add_u32 v26, v26, 5, v25
    v_xor_b32 v27, s59, v24
    v_lshl_add_u32 v27, v27, 5, v25
    ds_read_b128 a[92:95], v8 offset:0
    ds_read_b64_tr_b16 a[0:1], v26 offset:0
    ds_read_b64_tr_b16 a[2:3], v26 offset:1024
    ds_read_b64_tr_b16 a[32:33], v27 offset:0
    ds_read_b64_tr_b16 a[34:35], v27 offset:1024
    ds_read_b128 a[96:99], v9 offset:0
    ds_read_b64_tr_b16 a[4:5], v26 offset:8192
    ds_read_b64_tr_b16 a[6:7], v26 offset:9216
    ds_read_b64_tr_b16 a[36:37], v27 offset:8192
    ds_read_b64_tr_b16 a[38:39], v27 offset:9216
    ds_read_b128 a[100:103], v10 offset:0
    ds_read_b64_tr_b16 a[8:9], v26 offset:16384
    ds_read_b64_tr_b16 a[10:11], v26 offset:17408
    ds_read_b64_tr_b16 a[40:41], v27 offset:16384
    ds_read_b64_tr_b16 a[42:43], v27 offset:17408
    s_waitcnt lgkmcnt(10)
    v_mfma_f32_16x16x32_bf16 v[32:35], a[0:3], a[92:95], 0
    v_max3_f32 v24, v16, v18, v20
    v_max_f32 v24, v24, v22
    v_mfma_f32_16x16x32_bf16 v[36:39], a[32:35], a[92:95], 0
    v_sub_f32 v16, v16, v24
    v_sub_f32 v18, v18, v24
    ds_read_b128 a[104:107], v11 offset:0
    ds_read_b64_tr_b16 a[12:13], v26 offset:24576
    ds_read_b64_tr_b16 a[14:15], v26 offset:25600
    ds_read_b64_tr_b16 a[44:45], v27 offset:24576
    ds_read_b64_tr_b16 a[46:47], v27 offset:25600
    s_waitcnt lgkmcnt(10)
    v_mfma_f32_16x16x32_bf16 v[32:35], a[4:7], a[96:99], v[32:35]
    v_sub_f32 v20, v20, v24
    v_sub_f32 v22, v22, v24
    v_mfma_f32_16x16x32_bf16 v[36:39], a[36:39], a[96:99], v[36:39]
    v_exp_f32 v16, v16
    v_exp_f32 v18, v18
    ds_read_b128 a[108:111], v8 offset:256
    ds_read_b64_tr_b16 a[16:17], v26 offset:32768
    ds_read_b64_tr_b16 a[18:19], v26 offset:33792
    ds_read_b64_tr_b16 a[48:49], v27 offset:32768
    ds_read_b64_tr_b16 a[50:51], v27 offset:33792
    s_waitcnt lgkmcnt(10)
    v_mfma_f32_16x16x32_bf16 v[40:43], a[8:11], a[100:103], 0
    v_exp_f32 v20, v20
    v_exp_f32 v22, v22
    v_mfma_f32_16x16x32_bf16 v[44:47], a[40:43], a[100:103], 0
    v_min_u32 v24, -2, v24
    ds_read_b128 a[112:115], v9 offset:256
    ds_read_b64_tr_b16 a[20:21], v26 offset:40960
    ds_read_b64_tr_b16 a[22:23], v26 offset:41984
    ds_read_b64_tr_b16 a[52:53], v27 offset:40960
    ds_read_b64_tr_b16 a[54:55], v27 offset:41984
    s_waitcnt lgkmcnt(10)
    v_mfma_f32_16x16x32_bf16 v[40:43], a[12:15], a[104:107], v[40:43]
    v_mul_f32 v25, v16, v17
    v_mfma_f32_16x16x32_bf16 v[44:47], a[44:47], a[104:107], v[44:47]
    v_fma_f32 v25, v18, v19, v25
    ds_read_b128 a[116:119], v10 offset:256
    ds_read_b64_tr_b16 a[24:25], v26 offset:49152
    ds_read_b64_tr_b16 a[26:27], v26 offset:50176
    ds_read_b64_tr_b16 a[56:57], v27 offset:49152
    ds_read_b64_tr_b16 a[58:59], v27 offset:50176
    s_waitcnt lgkmcnt(10)
    v_mfma_f32_16x16x32_bf16 v[48:51], a[16:19], a[108:111], 0
    v_fma_f32 v25, v20, v21, v25
    v_mfma_f32_16x16x32_bf16 v[52:55], a[48:51], a[108:111], 0
    v_fma_f32 v25, v22, v23, v25
    ds_read_b128 a[120:123], v11 offset:256
    ds_read_b64_tr_b16 a[28:29], v26 offset:57344
    ds_read_b64_tr_b16 a[30:31], v26 offset:58368
    ds_read_b64_tr_b16 a[60:61], v27 offset:57344
    ds_read_b64_tr_b16 a[62:63], v27 offset:58368
    s_waitcnt lgkmcnt(10)
    v_mfma_f32_16x16x32_bf16 v[48:51], a[20:23], a[112:115], v[48:51]
    v_min_u32 v25, -2, v25
    v_mfma_f32_16x16x32_bf16 v[52:55], a[52:55], a[112:115], v[52:55]
    s_waitcnt lgkmcnt(5)
    v_mfma_f32_16x16x32_bf16 v[56:59], a[24:27], a[116:119], 0
    v_mfma_f32_16x16x32_bf16 v[60:63], a[56:59], a[116:119], 0
    s_waitcnt lgkmcnt(0)
    v_mfma_f32_16x16x32_bf16 v[56:59], a[28:31], a[120:123], v[56:59]
    v_mfma_f32_16x16x32_bf16 v[60:63], a[60:63], a[120:123], v[60:63]
    v_mov_b32 v30, 1
    s_mov_b64 exec, 1
    ds_write_b32 v3, v30 offset:80
    s_mov_b64 exec, -1
    s_branch La2d_11
La2_10:
    ds_read_b128 a[92:95], v8 offset:0
    ds_read_b128 a[96:99], v9 offset:0
    ds_read_b128 a[100:103], v10 offset:0
    ds_read_b128 a[104:107], v11 offset:0
    ds_read_b128 a[108:111], v8 offset:256
    ds_read_b128 a[112:115], v9 offset:256
    ds_read_b128 a[116:119], v10 offset:256
    ds_read_b128 a[120:123], v11 offset:256
    s_waitcnt lgkmcnt(6)
    v_mfma_f32_16x16x32_bf16 v[32:35], a[0:3], a[92:95], 0
    v_max3_f32 v24, v16, v18, v20
    v_max_f32 v24, v24, v22
    v_mfma_f32_16x16x32_bf16 v[36:39], a[32:35], a[92:95], 0
    v_sub_f32 v16, v16, v24
    v_sub_f32 v18, v18, v24
    v_mfma_f32_16x16x32_bf16 v[32:35], a[4:7], a[96:99], v[32:35]
    v_sub_f32 v20, v20, v24
    v_sub_f32 v22, v22, v24
    v_mfma_f32_16x16x32_bf16 v[36:39], a[36:39], a[96:99], v[36:39]
    v_exp_f32 v16, v16
    v_exp_f32 v18, v18
    s_waitcnt lgkmcnt(4)
    v_mfma_f32_16x16x32_bf16 v[40:43], a[8:11], a[100:103], 0
    v_exp_f32 v20, v20
    v_exp_f32 v22, v22
    v_mfma_f32_16x16x32_bf16 v[44:47], a[40:43], a[100:103], 0
    v_min_u32 v24, -2, v24
    v_mfma_f32_16x16x32_bf16 v[40:43], a[12:15], a[104:107], v[40:43]
    v_mul_f32 v25, v16, v17
    v_mfma_f32_16x16x32_bf16 v[44:47], a[44:47], a[104:107], v[44:47]
    v_fma_f32 v25, v18, v19, v25
    s_waitcnt lgkmcnt(2)
    v_mfma_f32_16x16x32_bf16 v[48:51], a[16:19], a[108:111], 0
    v_fma_f32 v25, v20, v21, v25
    v_mfma_f32_16x16x32_bf16 v[52:55], a[48:51], a[108:111], 0
    v_fma_f32 v25, v22, v23, v25
    v_mfma_f32_16x16x32_bf16 v[48:51], a[20:23], a[112:115], v[48:51]
    v_min_u32 v25, -2, v25
    v_mfma_f32_16x16x32_bf16 v[52:55], a[52:55], a[112:115], v[52:55]
    s_waitcnt lgkmcnt(0)
    v_mfma_f32_16x16x32_bf16 v[56:59], a[24:27], a[116:119], 0
    v_mfma_f32_16x16x32_bf16 v[60:63], a[56:59], a[116:119], 0
    v_mfma_f32_16x16x32_bf16 v[56:59], a[28:31], a[120:123], v[56:59]
    v_mfma_f32_16x16x32_bf16 v[60:63], a[60:63], a[120:123], v[60:63]
La2d_11:
    s_nop 2
    v_pk_mul_f32 v[32:33], v[32:33], v[16:17] op_sel_hi:[1,0]
    v_pk_mul_f32 v[34:35], v[34:35], v[16:17] op_sel_hi:[1,0]
    v_pk_mul_f32 v[36:37], v[36:37], v[16:17] op_sel_hi:[1,0]
    v_pk_mul_f32 v[38:39], v[38:39], v[16:17] op_sel_hi:[1,0]
    v_pk_fma_f32 v[32:33], v[40:41], v[18:19], v[32:33] op_sel_hi:[1,0,1]
    v_pk_fma_f32 v[34:35], v[42:43], v[18:19], v[34:35] op_sel_hi:[1,0,1]
    v_pk_fma_f32 v[36:37], v[44:45], v[18:19], v[36:37] op_sel_hi:[1,0,1]
    v_pk_fma_f32 v[38:39], v[46:47], v[18:19], v[38:39] op_sel_hi:[1,0,1]
    v_pk_fma_f32 v[32:33], v[48:49], v[20:21], v[32:33] op_sel_hi:[1,0,1]
    v_pk_fma_f32 v[34:35], v[50:51], v[20:21], v[34:35] op_sel_hi:[1,0,1]
    v_pk_fma_f32 v[36:37], v[52:53], v[20:21], v[36:37] op_sel_hi:[1,0,1]
    v_pk_fma_f32 v[38:39], v[54:55], v[20:21], v[38:39] op_sel_hi:[1,0,1]
    s_nop 1
    v_pk_fma_f32 v[32:33], v[56:57], v[22:23], v[32:33] op_sel_hi:[1,0,1]
    v_pk_fma_f32 v[34:35], v[58:59], v[22:23], v[34:35] op_sel_hi:[1,0,1]
    v_pk_fma_f32 v[36:37], v[60:61], v[22:23], v[36:37] op_sel_hi:[1,0,1]
    v_pk_fma_f32 v[38:39], v[62:63], v[22:23], v[38:39] op_sel_hi:[1,0,1]
    s_mov_b32 exec_lo, 0x000f000f
    s_mov_b32 exec_hi, 0x000f000f
    v_cvt_pk_bf16_f32 v26, v32, v33
    v_cvt_pk_bf16_f32 v27, v34, v35
    v_cvt_pk_bf16_f32 v28, v36, v37
    v_cvt_pk_bf16_f32 v29, v38, v39
    v_min_u32 v26, -2, v26
    v_min_u32 v27, -2, v27
    v_min_u32 v28, -2, v28
    v_min_u32 v29, -2, v29
    s_cmp_eq_u32 s57, 0
    s_cbranch_scc1 Lst_sc1_12
    buffer_store_dwordx2 v[26:27], v13, s[48:51], s5 offen
    buffer_store_dwordx2 v[28:29], v13, s[48:51], s5 offen offset:256
Lst_done_13:
    s_cmp_lg_u32 s32, 0
    s_cbranch_scc1 Lnostat_14
    s_mov_b64 exec, 0xf
    v_lshlrev_b32 v30, 6, v5
    s_cmp_eq_u32 s57, 0
    s_cbranch_scc1 Lst_sc1_15
    buffer_store_dword v24, v30, s[48:51], s10 offen
    buffer_store_dword v25, v30, s[48:51], s10 offen offset:32
Lst_done_16:
Lnostat_14:
    s_mov_b64 exec, -1
    s_cmp_eq_u32 s35, 0
    s_cbranch_scc1 Lg0_op_17
    s_barrier
Lgd_op_18:
    s_cmp_lg_u32 s35, 0
    s_cbranch_scc1 La3_19
    s_setprio 0
    s_cmp_eq_u32 s30, 7
    s_cbranch_scc1 La4_20
    s_mul_i32 s58, s29, 448
    s_lshl_b32 s59, s30, 6
    s_add_u32 s58, s58, s59
    s_add_u32 s40, s16, s58
    s_addc_u32 s41, s17, 0
    s_mov_b32 s42, 0x1bf240
    s_mov_b32 s43, 0x20000
    s_add_u32 s44, s18, s58
    s_addc_u32 s45, s19, 0
    s_mov_b32 s46, 0x1bf240
    s_mov_b32 s47, 0x20000
    v_lshrrev_b32 v24, 2, v0
    v_mul_u32_u24 v24, 0xe00, v24
    v_lshrrev_b32 v25, 5, v0
    v_xor_b32 v25, v25, v5
    v_lshl_add_u32 v26, v25, 4, v24
    v_xor_b32 v25, 2, v25
    v_lshl_add_u32 v27, v25, 4, v24
    s_lshl_b32 s60, s31, 1
    s_mov_b32 s56, 0
Lfw_vr_22:
    ds_read_b128 v[16:19], v4 offset:80
    s_waitcnt lgkmcnt(0)
    v_min3_u32 v16, v16, v17, v18
    v_min_u32 v16, v16, v19
    v_cmp_le_u32 vcc, 1, v16
    s_cbranch_vccnz Lfd_vr_23
    s_add_u32 s56, s56, 1
    s_cmp_lt_u32 s56, 0x61a80
    s_cbranch_scc1 Lfw_vr_22
    s_branch L_abort
Lfd_vr_23:
    s_add_u32 s61, s60, 0
    s_and_b32 s61, s61, 7
    s_lshl_b32 s99, s32, 3
    s_add_u32 s99, s99, s61
    s_lshl_b32 s98, s99, 10
    s_add_u32 s98, s98, 0x10000
    s_mov_b32 m0, s98
    s_mul_i32 s99, s99, 0xe000
    buffer_load_dwordx4 v26, s[40:43], s99 offen lds
    s_add_u32 s98, s98, 0x8000
    s_mov_b32 m0, s98
    s_nop 0
    buffer_load_dwordx4 v27, s[44:47], s99 offen lds
    s_waitcnt vmcnt(2)
    s_add_u32 s61, s60, 1
    s_and_b32 s61, s61, 7
    s_lshl_b32 s99, s32, 3
    s_add_u32 s99, s99, s61
    s_lshl_b32 s98, s99, 10
    s_add_u32 s98, s98, 0x10000
    s_mov_b32 m0, s98
    s_mul_i32 s99, s99, 0xe000
    buffer_load_dwordx4 v26, s[40:43], s99 offen lds
    s_add_u32 s98, s98, 0x8000
    s_mov_b32 m0, s98
    s_nop 0
    buffer_load_dwordx4 v27, s[44:47], s99 offen lds
    s_waitcnt vmcnt(2)
    s_add_u32 s61, s60, 2
    s_and_b32 s61, s61, 7
    s_lshl_b32 s99, s32, 3
    s_add_u32 s99, s99, s61
    s_lshl_b32 s98, s99, 10
    s_add_u32 s98, s98, 0x10000
    s_mov_b32 m0, s98
    s_mul_i32 s99, s99, 0xe000
    buffer_load_dwordx4 v26, s[40:43], s99 offen lds
    s_add_u32 s98, s98, 0x8000
    s_mov_b32 m0, s98
    s_nop 0
    buffer_load_dwordx4 v27, s[44:47], s99 offen lds
    s_waitcnt vmcnt(2)
    s_add_u32 s61, s60, 3
    s_and_b32 s61, s61, 7
    s_lshl_b32 s99, s32, 3
    s_add_u32 s99, s99, s61
    s_lshl_b32 s98, s99, 10
    s_add_u32 s98, s98, 0x10000
    s_mov_b32 m0, s98
    s_mul_i32 s99, s99, 0xe000
    buffer_load_dwordx4 v26, s[40:43], s99 offen lds
    s_add_u32 s98, s98, 0x8000
    s_mov_b32 m0, s98
    s_nop 0
    buffer_load_dwordx4 v27, s[44:47], s99 offen lds
    s_waitcnt vmcnt(2)
    s_add_u32 s61, s60, 4
    s_and_b32 s61, s61, 7
    s_lshl_b32 s99, s32, 3
    s_add_u32 s99, s99, s61
    s_lshl_b32 s98, s99, 10
    s_add_u32 s98, s98, 0x10000
    s_mov_b32 m0, s98
    s_mul_i32 s99, s99, 0xe000
    buffer_load_dwordx4 v26, s[40:43], s99 offen lds
    s_add_u32 s98, s98, 0x8000
    s_mov_b32 m0, s98
    s_nop 0
    buffer_load_dwordx4 v27, s[44:47], s99 offen lds
    s_waitcnt vmcnt(2)
    s_add_u32 s61, s60, 5
    s_and_b32 s61, s61, 7
    s_lshl_b32 s99, s32, 3
    s_add_u32 s99, s99, s61
    s_lshl_b32 s98, s99, 10
    s_add_u32 s98, s98, 0x10000
    s_mov_b32 m0, s98
    s_mul_i32 s99, s99, 0xe000
    buffer_load_dwordx4 v26, s[40:43], s99 offen lds
    s_add_u32 s98, s98, 0x8000
    s_mov_b32 m0, s98
    s_nop 0
    buffer_load_dwordx4 v27, s[44:47], s99 offen lds
    s_waitcnt vmcnt(2)
    s_add_u32 s61, s60, 6
    s_and_b32 s61, s61, 7
    s_lshl_b32 s99, s32, 3
    s_add_u32 s99, s99, s61
    s_lshl_b32 s98, s99, 10
    s_add_u32 s98, s98, 0x10000
    s_mov_b32 m0, s98
    s_mul_i32 s99, s99, 0xe000
    buffer_load_dwordx4 v26, s[40:43], s99 offen lds
    s_add_u32 s98, s98, 0x8000
    s_mov_b32 m0, s98
    s_nop 0
    buffer_load_dwordx4 v27, s[44:47], s99 offen lds
    s_waitcnt vmcnt(2)
    s_add_u32 s61, s60, 7
    s_and_b32 s61, s61, 7
    s_lshl_b32 s99, s32, 3
    s_add_u32 s99, s99, s61
    s_lshl_b32 s98, s99, 10
    s_add_u32 s98, s98, 0x10000
    s_mov_b32 m0, s98
    s_mul_i32 s99, s99, 0xe000
    buffer_load_dwordx4 v26, s[40:43], s99 offen lds
    s_add_u32 s98, s98, 0x8000
    s_mov_b32 m0, s98
    s_nop 0
    buffer_load_dwordx4 v27, s[44:47], s99 offen lds
    s_waitcnt vmcnt(2)
    s_branch La5_21
La4_20:
    s_mov_b32 s56, 0
Lfw_vr7_24:
    ds_read_b128 v[16:19], v4 offset:80
    s_waitcnt lgkmcnt(0)
    v_min3_u32 v16, v16, v17, v18
    v_min_u32 v16, v16, v19
    v_cmp_le_u32 vcc, 1, v16
    s_cbranch_vccnz Lfd_vr7_25
    s_add_u32 s56, s56, 1
    s_cmp_lt_u32 s56, 0x61a80
    s_cbranch_scc1 Lfw_vr7_24
    s_branch L_abort
Lfd_vr7_25:
La5_21:
    s_mul_i32 s58, s29, 0x38000
    s_lshl_b32 s59, s30, 7
    s_add_u32 s58, s58, s59
    s_add_u32 s36, s20, s58
    s_addc_u32 s37, s21, 0
    s_mov_b32 s38, 0x37c80
    s_mov_b32 s39, 0x20000
    v_lshrrev_b32 v24, 3, v0
    v_and_b32 v25, 7, v0
    v_and_b32 v26, 1, v2
    v_lshlrev_b32 v26, 1, v26
    v_xor_b32 v25, v25, v26
    v_lshlrev_b32 v25, 4, v25
    v_lshl_add_u32 v26, v24, 10, v25
    s_mul_i32 s59, s32, 7
    s_lshl_b32 s60, s31, 1
    s_add_u32 s61, s60, 0
    s_sub_u32 s58, s61, 7
    s_cmp_ge_u32 s61, 7
    s_cselect_b32 s61, s58, s61
    s_add_u32 s61, s61, s59
    s_and_b32 s58, s61, 1
    s_lshl_b32 s58, s58, 6
    v_xor_b32 v27, s58, v26
    s_lshl_b32 s98, s61, 10
    s_add_u32 s98, s98, 0x20000
    s_mov_b32 m0, s98
    s_lshl_b32 s99, s61, 13
    buffer_load_dwordx4 v27, s[36:39], s99 offen lds
    s_add_u32 s61, s60, 1
    s_sub_u32 s58, s61, 7
    s_cmp_ge_u32 s61, 7
    s_cselect_b32 s61, s58, s61
    s_add_u32 s61, s61, s59
    s_and_b32 s58, s61, 1
    s_lshl_b32 s58, s58, 6
    v_xor_b32 v27, s58, v26
    s_lshl_b32 s98, s61, 10
    s_add_u32 s98, s98, 0x20000
    s_mov_b32 m0, s98
    s_lshl_b32 s99, s61, 13
    buffer_load_dwordx4 v27, s[36:39], s99 offen lds
    s_add_u32 s61, s60, 2
    s_sub_u32 s58, s61, 7
    s_cmp_ge_u32 s61, 7
    s_cselect_b32 s61, s58, s61
    s_add_u32 s61, s61, s59
    s_and_b32 s58, s61, 1
    s_lshl_b32 s58, s58, 6
    v_xor_b32 v27, s58, v26
    s_lshl_b32 s98, s61, 10
    s_add_u32 s98, s98, 0x20000
    s_mov_b32 m0, s98
    s_lshl_b32 s99, s61, 13
    buffer_load_dwordx4 v27, s[36:39], s99 offen lds
    s_add_u32 s61, s60, 3
    s_sub_u32 s58, s61, 7
    s_cmp_ge_u32 s61, 7
    s_cselect_b32 s61, s58, s61
    s_add_u32 s61, s61, s59
    s_and_b32 s58, s61, 1
    s_lshl_b32 s58, s58, 6
    v_xor_b32 v27, s58, v26
    s_lshl_b32 s98, s61, 10
    s_add_u32 s98, s98, 0x20000
    s_mov_b32 m0, s98
    s_lshl_b32 s99, s61, 13
    buffer_load_dwordx4 v27, s[36:39], s99 offen lds
    s_add_u32 s61, s60, 4
    s_sub_u32 s58, s61, 7
    s_cmp_ge_u32 s61, 7
    s_cselect_b32 s61, s58, s61
    s_add_u32 s61, s61, s59
    s_and_b32 s58, s61, 1
    s_lshl_b32 s58, s58, 6
    v_xor_b32 v27, s58, v26
    s_lshl_b32 s98, s61, 10
    s_add_u32 s98, s98, 0x20000
    s_mov_b32 m0, s98
    s_lshl_b32 s99, s61, 13
    buffer_load_dwordx4 v27, s[36:39], s99 offen lds
    s_add_u32 s61, s60, 5
    s_sub_u32 s58, s61, 7
    s_cmp_ge_u32 s61, 7
    s_cselect_b32 s61, s58, s61
    s_add_u32 s61, s61, s59
    s_and_b32 s58, s61, 1
    s_lshl_b32 s58, s58, 6
    v_xor_b32 v27, s58, v26
    s_lshl_b32 s98, s61, 10
    s_add_u32 s98, s98, 0x20000
    s_mov_b32 m0, s98
    s_lshl_b32 s99, s61, 13
    buffer_load_dwordx4 v27, s[36:39], s99 offen lds
    s_add_u32 s61, s60, 6
    s_sub_u32 s58, s61, 7
    s_cmp_ge_u32 s61, 7
    s_cselect_b32 s61, s58, s61
    s_add_u32 s61, s61, s59
    s_and_b32 s58, s61, 1
    s_lshl_b32 s58, s58, 6
    v_xor_b32 v27, s58, v26
    s_lshl_b32 s98, s61, 10
    s_add_u32 s98, s98, 0x20000
    s_mov_b32 m0, s98
    s_lshl_b32 s99, s61, 13
    buffer_load_dwordx4 v27, s[36:39], s99 offen lds
    v_lshrrev_b32 v24, 2, v1
    v_lshl_add_u32 v25, v2, 3, v24
    v_lshlrev_b32 v25, 7, v25
    v_lshrrev_b32 v24, 1, v24
    v_and_b32 v26, 1, v2
    v_lshl_or_b32 v24, v26, 1, v24
    v_xor_b32 v24, s32, v24
    v_lshl_add_u32 v25, v24, 5, v25
    v_and_b32 v24, 1, v5
    v_lshl_add_u32 v25, v24, 3, v25
    v_lshrrev_b32 v24, 1, v5
    v_lshl_add_u32 v25, v24, 4, v25
    v_add_u32 v25, 0x20000, v25
    s_waitcnt vmcnt(7)
    v_mov_b32 v24, 1
    s_mov_b64 exec, 1
    ds_write_b32 v3, v24 offset:112
    s_mov_b64 exec, -1
    s_waitcnt vmcnt(0)
    v_mov_b32 v24, 1
    s_mov_b64 exec, 1
    ds_write_b32 v3, v24 offset:128
    s_mov_b64 exec, -1
    s_mov_b32 s56, 0
Lfw_dn_26:
    ds_read_b128 v[16:19], v4 offset:128
    s_waitcnt lgkmcnt(0)
    v_min3_u32 v16, v16, v17, v18
    v_min_u32 v16, v16, v19
    v_cmp_le_u32 vcc, 1, v16
    s_cbranch_vccnz Lfd_dn_27
    s_add_u32 s56, s56, 1
    s_cmp_lt_u32 s56, 0x61a80
    s_cbranch_scc1 Lfw_dn_26
    s_branch L_abort
Lfd_dn_27:
    ds_read_b64_tr_b16 a[64:65], v25 offset:0
    ds_read_b64_tr_b16 a[66:67], v25 offset:512
    ds_read_b64_tr_b16 a[68:69], v25 offset:4096
    ds_read_b64_tr_b16 a[70:71], v25 offset:4608
    ds_read_b64_tr_b16 a[72:73], v25 offset:8192
    ds_read_b64_tr_b16 a[74:75], v25 offset:8704
    ds_read_b64_tr_b16 a[76:77], v25 offset:12288
    ds_read_b64_tr_b16 a[78:79], v25 offset:12800
    ds_read_b64_tr_b16 a[80:81], v25 offset:16384
    ds_read_b64_tr_b16 a[82:83], v25 offset:16896
    ds_read_b64_tr_b16 a[84:85], v25 offset:20480
    ds_read_b64_tr_b16 a[86:87], v25 offset:20992
    ds_read_b64_tr_b16 a[88:89], v25 offset:24576
    ds_read_b64_tr_b16 a[90:91], v25 offset:25088
La3_19:
    s_cmp_eq_u32 s35, 0
    s_cbranch_scc1 Lb1_28
    s_barrier
Lb1_28:
    s_cmp_eq_u32 s35, 0
    s_cbranch_scc1 Lb1_29
    s_barrier
Lb1_29:
    s_cmp_eq_u32 s35, 0
    s_cbranch_scc1 Lb1_30
    s_barrier
Lb1_30:
    s_barrier
    s_mov_b32 exec_lo, 0x007f007f
    s_mov_b32 exec_hi, 0x007f007f
    s_waitcnt lgkmcnt(0)
    s_mov_b32 s56, 0
Lpoll_h_31:
    buffer_load_dwordx4 v[20:23], v14, s[48:51], s11 offen sc1
    s_waitcnt vmcnt(0)
    v_max3_u32 v24, v20, v21, v22
    v_max_u32 v24, v24, v23
    v_cmp_eq_u32 vcc, -1, v24
    s_cbranch_vccnz Lretry_h_32
    s_mov_b64 exec, -1
    v_mfma_f32_16x16x32_bf16 v[32:35], v[20:23], a[64:67], 0
    v_mfma_f32_16x16x32_bf16 v[36:39], v[20:23], a[68:71], 0
    v_mfma_f32_16x16x32_bf16 v[40:43], v[20:23], a[72:75], 0
    v_mfma_f32_16x16x32_bf16 v[44:47], v[20:23], a[76:79], 0
    v_mfma_f32_16x16x32_bf16 v[48:51], v[20:23], a[80:83], 0
    v_mfma_f32_16x16x32_bf16 v[52:55], v[20:23], a[84:87], 0
    v_mfma_f32_16x16x32_bf16 v[56:59], v[20:23], a[88:91], 0
    s_nop 3
    v_add_f32 v16, v32, v37
    v_add_f32 v17, v42, v47
    v_add_f32 v16, v16, v17
    v_add_f32 v24, v48, v53
    s_nop 0
    v_add_f32 v24, v24, v58
    s_nop 1
    v_permlane16_swap_b32 v24, v25
    v_add_f32 v16, v16, v25
    s_nop 1
    v_mov_b32_dpp v18, v16 quad_perm:[1,0,3,2] row_mask:0xf bank_mask:0xf
    s_mov_b64 exec, 0x5555
    v_cvt_pk_bf16_f32 v18, v16, v18
    v_min_u32 v18, -2, v18
    ds_write_b32 v15, v18
    s_mov_b64 exec, -1
    v_lshlrev_b32 v26, 2, v0
    v_and_b32 v27, 0x7f, v26
    v_add_u32 v27, 0x27d40, v27
    s_waitcnt lgkmcnt(0)
    s_barrier
    s_cmp_lg_u32 s32, 0
    s_cbranch_scc1 Lnod_33
    ds_read_b32 v18, v27
    s_waitcnt lgkmcnt(0)
    s_mov_b32 exec_lo, -1
    s_mov_b32 exec_hi, 0
    buffer_store_dword v18, v26, s[48:51], s12 offen sc1
    s_mov_b64 exec, -1
    s_cmp_lg_u32 s35, 0
    s_cbranch_scc1 Lx5f_34
    s_waitcnt vmcnt(0)
    s_branch Lnod_33
Lx5f_34:
    s_add_u32 s58, s29, s30
    s_cmp_lg_u32 s58, 0
    s_cbranch_scc1 L_fin
    s_waitcnt vmcnt(0)
    s_barrier
    s_branch L_fin
Lnod_33:
    s_cmp_lg_u32 s35, 0
    s_cbranch_scc1 L_fin
    s_barrier
    s_add_u32 s4, s4, 0x80000
    s_add_u32 s5, s5, 0x80000
    s_add_u32 s10, s10, 0x80000
    s_add_u32 s11, s11, 0x80000
    s_add_u32 s12, s12, 0x80000
    s_mov_b32 s35, 1
    s_branch L_A_loop
L_W:
    s_setprio 3
    v_mov_b32 v16, -1
    v_mov_b32 v17, -1
    v_mov_b32 v18, -1
    v_mov_b32 v19, -1
    s_cmp_ge_u32 s32, 2
    s_cbranch_scc1 Lclr01_35
    s_mul_i32 s58, s32, 0x80000
    s_lshl_b32 s59, s63, 13
    s_add_u32 s58, s58, s59
    s_lshl_b32 s59, s30, 10
    s_add_u32 s58, s58, s59
    s_add_u32 s58, s58, 0x30000
    v_lshlrev_b32 v13, 4, v0
    buffer_store_dwordx4 v[16:19], v13, s[48:51], s58 offen sc1
    s_branch Lclrd_37
Lclr01_35:
    v_bfe_u32 v13, v0, 3, 1
    v_mul_u32_u24 v13, 0x80000, v13
    v_and_b32 v14, 7, v0
    v_lshl_add_u32 v14, v14, 4, v13
    s_cmp_eq_u32 s32, 3
    s_cbranch_scc1 Lclr3_36
    v_and_b32 v15, 7, v0
    v_lshl_add_u32 v15, v15, 6, v13
    s_and_b32 s58, s30, 1
    s_lshl_b32 s58, s58, 9
    s_lshr_b32 s59, s30, 1
    s_lshl_b32 s59, s59, 4
    s_add_u32 s58, s58, s59
    s_lshl_b32 s59, s63, 10
    s_add_u32 s58, s58, s59
    s_add_u32 s58, s58, 0x10000
    s_mov_b64 exec, 0xffff
    buffer_store_dwordx4 v[16:19], v15, s[48:51], s58 offen sc1
    s_lshl_b32 s58, s63, 9
    s_lshl_b32 s59, s30, 6
    s_add_u32 s58, s58, s59
    s_add_u32 s58, s58, 0x28000
    s_mov_b64 exec, 0xf0f
    buffer_store_dwordx4 v[16:19], v14, s[48:51], s58 offen sc1
    s_mov_b64 exec, -1
    s_branch Lclrd_37
Lclr3_36:
    s_lshl_b32 s58, s31, 13
    s_lshl_b32 s59, s29, 10
    s_add_u32 s58, s58, s59
    s_lshl_b32 s59, s30, 7
    s_add_u32 s58, s58, s59
    s_add_u32 s58, s58, 0x18000
    s_mov_b64 exec, 0xffff
    buffer_store_dwordx4 v[16:19], v14, s[48:51], s58 offen sc1
    s_add_u32 s58, s58, 0x8000
    buffer_store_dwordx4 v[16:19], v14, s[48:51], s58 offen sc1
    s_lshl_b32 s58, s63, 8
    s_lshl_b32 s59, s30, 5
    s_add_u32 s58, s58, s59
    s_add_u32 s58, s58, 0x2c000
    s_mov_b64 exec, 0x303
    buffer_store_dwordx4 v[16:19], v14, s[48:51], s58 offen sc1
    s_mov_b64 exec, -1
Lclrd_37:
    s_lshl_b32 s58, s31, 10
    s_add_u32 s52, s4, s58
    s_addc_u32 s53, s5, 0
    s_mov_b32 s54, 0x400
    s_mov_b32 s55, 0x20000
    v_lshlrev_b32 v3, 4, v1
    v_lshl_add_u32 v3, v2, 2, v3
    s_lshl_b32 s58, s32, 8
    buffer_load_dword v20, v3, s[52:55], s58 offen
    s_lshl_b32 s58, s29, 10
    s_lshl_b32 s59, s30, 7
    s_add_u32 s58, s58, s59
    s_add_u32 s36, s10, s58
    s_addc_u32 s37, s11, 0
    s_mov_b32 s38, 0x3fe080
    s_mov_b32 s39, 0x20000
    v_lshrrev_b32 v21, 3, v0
    v_and_b32 v22, 7, v0
    v_and_b32 v13, 1, v2
    v_lshlrev_b32 v13, 1, v13
    v_xor_b32 v22, v22, v13
    v_lshlrev_b32 v22, 4, v22
    v_lshl_add_u32 v23, v21, 13, v22
    v_xor_b32 v24, 64, v23
    s_lshl_b32 s60, s31, 2
    s_add_u32 s61, s60, 0
    s_and_b32 s61, s61, 15
    s_lshl_b32 s99, s32, 4
    s_add_u32 s99, s99, s61
    s_lshl_b32 s98, s99, 10
    s_mov_b32 m0, s98
    s_lshl_b32 s99, s99, 16
    buffer_load_dwordx4 v23, s[36:39], s99 offen lds
    s_add_u32 s61, s60, 1
    s_and_b32 s61, s61, 15
    s_lshl_b32 s99, s32, 4
    s_add_u32 s99, s99, s61
    s_lshl_b32 s98, s99, 10
    s_mov_b32 m0, s98
    s_lshl_b32 s99, s99, 16
    buffer_load_dwordx4 v24, s[36:39], s99 offen lds
    s_add_u32 s61, s60, 2
    s_and_b32 s61, s61, 15
    s_lshl_b32 s99, s32, 4
    s_add_u32 s99, s99, s61
    s_lshl_b32 s98, s99, 10
    s_mov_b32 m0, s98
    s_lshl_b32 s99, s99, 16
    buffer_load_dwordx4 v23, s[36:39], s99 offen lds
    s_add_u32 s61, s60, 3
    s_and_b32 s61, s61, 15
    s_lshl_b32 s99, s32, 4
    s_add_u32 s99, s99, s61
    s_lshl_b32 s98, s99, 10
    s_mov_b32 m0, s98
    s_lshl_b32 s99, s99, 16
    buffer_load_dwordx4 v24, s[36:39], s99 offen lds
    s_add_u32 s61, s60, 4
    s_and_b32 s61, s61, 15
    s_lshl_b32 s99, s32, 4
    s_add_u32 s99, s99, s61
    s_lshl_b32 s98, s99, 10
    s_mov_b32 m0, s98
    s_lshl_b32 s99, s99, 16
    buffer_load_dwordx4 v23, s[36:39], s99 offen lds
    s_add_u32 s61, s60, 5
    s_and_b32 s61, s61, 15
    s_lshl_b32 s99, s32, 4
    s_add_u32 s99, s99, s61
    s_lshl_b32 s98, s99, 10
    s_mov_b32 m0, s98
    s_lshl_b32 s99, s99, 16
    buffer_load_dwordx4 v24, s[36:39], s99 offen lds
    s_add_u32 s61, s60, 6
    s_and_b32 s61, s61, 15
    s_lshl_b32 s99, s32, 4
    s_add_u32 s99, s99, s61
    s_lshl_b32 s98, s99, 10
    s_mov_b32 m0, s98
    s_lshl_b32 s99, s99, 16
    buffer_load_dwordx4 v23, s[36:39], s99 offen lds
    s_add_u32 s61, s60, 7
    s_and_b32 s61, s61, 15
    s_lshl_b32 s99, s32, 4
    s_add_u32 s99, s99, s61
    s_lshl_b32 s98, s99, 10
    s_mov_b32 m0, s98
    s_lshl_b32 s99, s99, 16
    buffer_load_dwordx4 v24, s[36:39], s99 offen lds
    s_add_u32 s61, s60, 8
    s_and_b32 s61, s61, 15
    s_lshl_b32 s99, s32, 4
    s_add_u32 s99, s99, s61
    s_lshl_b32 s98, s99, 10
    s_mov_b32 m0, s98
    s_lshl_b32 s99, s99, 16
    buffer_load_dwordx4 v23, s[36:39], s99 offen lds
    s_add_u32 s61, s60, 9
    s_and_b32 s61, s61, 15
    s_lshl_b32 s99, s32, 4
    s_add_u32 s99, s99, s61
    s_lshl_b32 s98, s99, 10
    s_mov_b32 m0, s98
    s_lshl_b32 s99, s99, 16
    buffer_load_dwordx4 v24, s[36:39], s99 offen lds
    s_add_u32 s61, s60, 10
    s_and_b32 s61, s61, 15
    s_lshl_b32 s99, s32, 4
    s_add_u32 s99, s99, s61
    s_lshl_b32 s98, s99, 10
    s_mov_b32 m0, s98
    s_lshl_b32 s99, s99, 16
    buffer_load_dwordx4 v23, s[36:39], s99 offen lds
    s_add_u32 s61, s60, 11
    s_and_b32 s61, s61, 15
    s_lshl_b32 s99, s32, 4
    s_add_u32 s99, s99, s61
    s_lshl_b32 s98, s99, 10
    s_mov_b32 m0, s98
    s_lshl_b32 s99, s99, 16
    buffer_load_dwordx4 v24, s[36:39], s99 offen lds
    s_add_u32 s61, s60, 12
    s_and_b32 s61, s61, 15
    s_lshl_b32 s99, s32, 4
    s_add_u32 s99, s99, s61
    s_lshl_b32 s98, s99, 10
    s_mov_b32 m0, s98
    s_lshl_b32 s99, s99, 16
    buffer_load_dwordx4 v23, s[36:39], s99 offen lds
    s_add_u32 s61, s60, 13
    s_and_b32 s61, s61, 15
    s_lshl_b32 s99, s32, 4
    s_add_u32 s99, s99, s61
    s_lshl_b32 s98, s99, 10
    s_mov_b32 m0, s98
    s_lshl_b32 s99, s99, 16
    buffer_load_dwordx4 v24, s[36:39], s99 offen lds
    s_add_u32 s61, s60, 14
    s_and_b32 s61, s61, 15
    s_lshl_b32 s99, s32, 4
    s_add_u32 s99, s99, s61
    s_lshl_b32 s98, s99, 10
    s_mov_b32 m0, s98
    s_lshl_b32 s99, s99, 16
    buffer_load_dwordx4 v23, s[36:39], s99 offen lds
    s_add_u32 s61, s60, 15
    s_and_b32 s61, s61, 15
    s_lshl_b32 s99, s32, 4
    s_add_u32 s99, s99, s61
    s_lshl_b32 s98, s99, 10
    s_mov_b32 m0, s98
    s_lshl_b32 s99, s99, 16
    buffer_load_dwordx4 v24, s[36:39], s99 offen lds
    s_and_b32 s58, s30, 1
    s_lshl_b32 s58, s58, 9
    s_lshr_b32 s59, s30, 1
    s_lshl_b32 s59, s59, 4
    s_add_u32 s58, s58, s59
    s_lshl_b32 s59, s63, 10
    s_add_u32 s58, s58, s59
    s_lshl_b32 s59, s32, 7
    s_add_u32 s58, s58, s59
    s_add_u32 s4, s58, 0x10000
    s_lshl_b32 s58, s63, 13
    s_lshl_b32 s59, s32, 11
    s_add_u32 s58, s58, s59
    s_add_u32 s5, s58, 0x30000
    s_lshl_b32 s58, s63, 8
    s_lshl_b32 s59, s32, 6
    s_add_u32 s58, s58, s59
    s_add_u32 s6, s58, 0x2c000
    s_lshl_b32 s58, s31, 13
    s_lshl_b32 s59, s29, 10
    s_add_u32 s58, s58, s59
    s_lshl_b32 s59, s30, 7
    s_add_u32 s58, s58, s59
    s_add_u32 s7, s58, 0x18000
    s_lshl_b32 s58, s31, 13
    s_lshl_b32 s59, s32, 8
    s_add_u32 s58, s58, s59
    s_add_u32 s8, s58, 0x18000
    s_add_u32 s9, s8, 4096
    s_add_u32 s11, s8, 0x8000
    s_add_u32 s14, s9, 0x8000
    s_lshl_b32 s58, s63, 9
    s_lshl_b32 s59, s30, 4
    s_add_u32 s58, s58, s59
    s_lshl_b32 s59, s32, 7
    s_add_u32 s58, s58, s59
    s_add_u32 s10, s58, 0x28000
    s_lshl_b32 s58, s32, 2
    s_add_u32 s58, s58, 0x27c40
    v_mov_b32 v6, s58
    v_mov_b32 v7, 0x27c40
    v_lshlrev_b32 v10, 1, v0
    v_lshlrev_b32 v9, 4, v1
    v_lshl_add_u32 v9, v2, 10, v9
    v_lshrrev_b32 v13, 2, v1
    v_and_b32 v14, 3, v0
    v_lshl_add_u32 v11, v2, 3, v13
    v_lshlrev_b32 v11, 7, v11
    v_lshrrev_b32 v12, 1, v13
    v_and_b32 v15, 1, v2
    v_lshl_or_b32 v12, v15, 1, v12
    v_and_b32 v15, 1, v14
    v_lshl_add_u32 v11, v15, 3, v11
    v_lshrrev_b32 v15, 1, v14
    v_lshl_add_u32 v11, v15, 4, v11
    v_cmp_eq_u32 vcc, 1, v1
    v_mov_b32 v13, 0x27000
    v_mov_b32 v14, 0x27440
    v_cndmask_b32 v13, v13, v14, vcc
    v_lshl_add_u32 v8, v2, 4, v13
    s_waitcnt vmcnt(16)
    v_lshlrev_b32 v4, 16, v20
    v_and_b32 v5, 0xffff0000, v20
    s_lshl_b32 s58, s32, 8
    s_add_u32 s58, s58, 0x27000
    v_add_u32 v3, s58, v3
    ds_write_b32 v3, v20
    v_mov_b32 v13, 0x3f803f80
    ds_write_b32 v3, v13 offset:1088
    v_mov_b32 v14, 1
    s_mov_b64 exec, 1
    ds_write_b32 v6, v14 offset:32
    s_mov_b64 exec, -1
    s_waitcnt lgkmcnt(0)
    s_add_u32 s34, s34, 1
    s_cmp_lg_u32 s32, 0
    s_cbranch_scc1 Lnoflag_38
    s_mov_b32 s56, 0
Lfw_clr_40:
    ds_read_b128 v[16:19], v7 offset:32
    s_waitcnt lgkmcnt(0)
    v_min3_u32 v16, v16, v17, v18
    v_min_u32 v16, v16, v19
    v_cmp_le_u32 vcc, 1, v16
    s_cbranch_vccnz Lfd_clr_41
    s_add_u32 s56, s56, 1
    s_cmp_lt_u32 s56, 0x61a80
    s_cbranch_scc1 Lfw_clr_40
    s_branch L_abort
Lfd_clr_41:
    s_lshl_b32 s58, s31, 6
    s_lshl_b32 s59, s29, 3
    s_add_u32 s58, s58, s59
    s_add_u32 s58, s58, s30
    s_lshl_b32 s58, s58, 7
    s_add_u32 s58, s58, 0x1000
    v_mov_b32 v16, s34
    v_mov_b32 v17, s33
    v_mov_b32 v18, 0
    s_mov_b64 exec, 1
    buffer_store_dwordx2 v[16:17], v18, s[48:51], s58 offen sc1
    s_mov_b64 exec, -1
    s_waitcnt vmcnt(1)
    s_branch Lsk_39
Lnoflag_38:
    s_waitcnt vmcnt(0)
Lsk_39:
    v_mov_b32 v14, 1
    s_mov_b64 exec, 1
    ds_write_b32 v6, v14 offset:0
    s_mov_b64 exec, -1
    s_mov_b32 s56, 0
Lfw_wq_42:
    ds_read_b128 v[16:19], v7 offset:0
    s_waitcnt lgkmcnt(0)
    v_min3_u32 v16, v16, v17, v18
    v_min_u32 v16, v16, v19
    v_cmp_le_u32 vcc, 1, v16
    s_cbranch_vccnz Lfd_wq_43
    s_add_u32 s56, s56, 1
    s_cmp_lt_u32 s56, 0x61a80
    s_cbranch_scc1 Lfw_wq_42
    s_branch L_abort
Lfd_wq_43:
    v_xor_b32 v13, s32, v12
    v_lshl_add_u32 v13, v13, 5, v11
    ds_read_b64_tr_b16 a[0:1], v13 offset:0
    ds_read_b64_tr_b16 a[2:3], v13 offset:512
    ds_read_b64_tr_b16 a[4:5], v13 offset:4096
    ds_read_b64_tr_b16 a[6:7], v13 offset:4608
    ds_read_b64_tr_b16 a[8:9], v13 offset:8192
    ds_read_b64_tr_b16 a[10:11], v13 offset:8704
    ds_read_b64_tr_b16 a[12:13], v13 offset:12288
    ds_read_b64_tr_b16 a[14:15], v13 offset:12800
    ds_read_b64_tr_b16 a[16:17], v13 offset:16384
    ds_read_b64_tr_b16 a[18:19], v13 offset:16896
    ds_read_b64_tr_b16 a[20:21], v13 offset:20480
    ds_read_b64_tr_b16 a[22:23], v13 offset:20992
    ds_read_b64_tr_b16 a[24:25], v13 offset:24576
    ds_read_b64_tr_b16 a[26:27], v13 offset:25088
    ds_read_b64_tr_b16 a[28:29], v13 offset:28672
    ds_read_b64_tr_b16 a[30:31], v13 offset:29184
    ds_read_b64_tr_b16 a[32:33], v13 offset:32768
    ds_read_b64_tr_b16 a[34:35], v13 offset:33280
    ds_read_b64_tr_b16 a[36:37], v13 offset:36864
    ds_read_b64_tr_b16 a[38:39], v13 offset:37376
    ds_read_b64_tr_b16 a[40:41], v13 offset:40960
    ds_read_b64_tr_b16 a[42:43], v13 offset:41472
    ds_read_b64_tr_b16 a[44:45], v13 offset:45056
    ds_read_b64_tr_b16 a[46:47], v13 offset:45568
    ds_read_b64_tr_b16 a[48:49], v13 offset:49152
    ds_read_b64_tr_b16 a[50:51], v13 offset:49664
    ds_read_b64_tr_b16 a[52:53], v13 offset:53248
    ds_read_b64_tr_b16 a[54:55], v13 offset:53760
    ds_read_b64_tr_b16 a[56:57], v13 offset:57344
    ds_read_b64_tr_b16 a[58:59], v13 offset:57856
    ds_read_b64_tr_b16 a[60:61], v13 offset:61440
    ds_read_b64_tr_b16 a[62:63], v13 offset:61952
    s_waitcnt lgkmcnt(0)
    v_mov_b32 v14, 1
    s_mov_b64 exec, 1
    ds_write_b32 v6, v14 offset:16
    s_mov_b64 exec, -1
    v_lshrrev_b32 v15, 3, v1
    v_lshlrev_b32 v15, 6, v15
    v_and_b32 v13, 7, v0
    v_lshl_add_u32 v15, v13, 1, v15
    s_lshl_b32 s58, s32, 2
    s_add_u32 s58, s58, 0x27840
    v_lshlrev_b32 v14, 4, v0
    v_add_u32 v14, 0x27000, v14
    v_lshlrev_b32 v13, 4, v0
    v_add_u32 v13, s58, v13
    s_mov_b32 s56, 0
Lfw_xb0_44:
    ds_read_b128 v[16:19], v7 offset:32
    s_waitcnt lgkmcnt(0)
    v_min3_u32 v16, v16, v17, v18
    v_min_u32 v16, v16, v19
    v_cmp_le_u32 vcc, 1, v16
    s_cbranch_vccnz Lfd_xb0_45
    s_add_u32 s56, s56, 1
    s_cmp_lt_u32 s56, 0x61a80
    s_cbranch_scc1 Lfw_xb0_44
    s_branch L_abort
Lfd_xb0_45:
    s_cmp_eq_u32 s30, 7
    s_cselect_b32 s96, 1, 0
L_W_loop:
    ds_read_b128 v[24:27], v14
    ds_read_b128 v[32:35], v8 offset:0
    ds_read_b128 v[36:39], v8 offset:64
    ds_read_b128 v[40:43], v8 offset:128
    ds_read_b128 v[44:47], v8 offset:192
    ds_read_b128 v[48:51], v8 offset:256
    ds_read_b128 v[52:55], v8 offset:320
    ds_read_b128 v[56:59], v8 offset:384
    ds_read_b128 v[60:63], v8 offset:448
    s_mov_b32 s100, 0x3f803f80
    v_mov_b32 v21, 0x3b000000
    s_waitcnt lgkmcnt(6)
    v_mfma_f32_16x16x32_bf16 v[16:19], v[32:35], a[0:3], 0
    ds_read_b128 v[32:35], v8 offset:512
    v_dot2_f32_bf16 v28, v24, s100, 0
    v_dot2_f32_bf16 v29, v24, v24, 0
    v_mfma_f32_16x16x32_bf16 v[16:19], v[36:39], a[4:7], v[16:19]
    ds_read_b128 v[36:39], v8 offset:576
    v_dot2_f32_bf16 v28, v25, s100, v28
    v_dot2_f32_bf16 v29, v25, v25, v29
    s_waitcnt lgkmcnt(6)
    v_mfma_f32_16x16x32_bf16 v[16:19], v[40:43], a[8:11], v[16:19]
    ds_read_b128 v[40:43], v8 offset:640
    v_dot2_f32_bf16 v28, v26, s100, v28
    v_dot2_f32_bf16 v29, v26, v26, v29
    v_mfma_f32_16x16x32_bf16 v[16:19], v[44:47], a[12:15], v[16:19]
    ds_read_b128 v[44:47], v8 offset:704
    v_dot2_f32_bf16 v28, v27, s100, v28
    v_dot2_f32_bf16 v29, v27, v27, v29
    s_waitcnt lgkmcnt(6)
    v_mfma_f32_16x16x32_bf16 v[16:19], v[48:51], a[16:19], v[16:19]
    ds_read_b128 v[48:51], v8 offset:768
    v_add_f32_dpp v28, v28, v28 row_shr:1 row_mask:0xf bank_mask:0xf bound_ctrl:0
    v_add_f32_dpp v29, v29, v29 row_shr:1 row_mask:0xf bank_mask:0xf bound_ctrl:0
    v_mfma_f32_16x16x32_bf16 v[16:19], v[52:55], a[20:23], v[16:19]
    ds_read_b128 v[52:55], v8 offset:832
    v_add_f32_dpp v28, v28, v28 row_shr:2 row_mask:0xf bank_mask:0xf bound_ctrl:0
    v_add_f32_dpp v29, v29, v29 row_shr:2 row_mask:0xf bank_mask:0xf bound_ctrl:0
    s_waitcnt lgkmcnt(6)
    v_mfma_f32_16x16x32_bf16 v[16:19], v[56:59], a[24:27], v[16:19]
    ds_read_b128 v[56:59], v8 offset:896
    v_add_f32_dpp v28, v28, v28 row_shr:4 row_mask:0xf bank_mask:0xf bound_ctrl:0
    v_add_f32_dpp v29, v29, v29 row_shr:4 row_mask:0xf bank_mask:0xf bound_ctrl:0
    v_mfma_f32_16x16x32_bf16 v[16:19], v[60:63], a[28:31], v[16:19]
    ds_read_b128 v[60:63], v8 offset:960
    v_add_f32_dpp v28, v28, v28 row_shr:8 row_mask:0xf bank_mask:0xf bound_ctrl:0
    v_add_f32_dpp v29, v29, v29 row_shr:8 row_mask:0xf bank_mask:0xf bound_ctrl:0
    s_waitcnt lgkmcnt(6)
    v_mfma_f32_16x16x32_bf16 v[16:19], v[32:35], a[32:35], v[16:19]
    v_add_f32_dpp v28, v28, v28 row_bcast:15 row_mask:0xa bank_mask:0xf
    v_add_f32_dpp v29, v29, v29 row_bcast:15 row_mask:0xa bank_mask:0xf
    v_mfma_f32_16x16x32_bf16 v[16:19], v[36:39], a[36:39], v[16:19]
    v_add_f32_dpp v28, v28, v28 row_bcast:31 row_mask:0xc bank_mask:0xf
    v_add_f32_dpp v29, v29, v29 row_bcast:31 row_mask:0xc bank_mask:0xf
    s_waitcnt lgkmcnt(4)
    v_mfma_f32_16x16x32_bf16 v[16:19], v[40:43], a[40:43], v[16:19]
    s_nop 0
    v_readlane_b32 s60, v28, 63
    v_readlane_b32 s61, v29, 63
    v_mfma_f32_16x16x32_bf16 v[16:19], v[44:47], a[44:47], v[16:19]
    v_mul_f32 v30, s60, v21
    v_mul_f32 v31, s61, v21
    s_waitcnt lgkmcnt(2)
    v_mfma_f32_16x16x32_bf16 v[16:19], v[48:51], a[48:51], v[16:19]
    v_fma_f32 v31, -v30, v30, v31
    v_mfma_f32_16x16x32_bf16 v[16:19], v[52:55], a[52:55], v[16:19]
    v_max_f32 v31, 0, v31
    s_waitcnt lgkmcnt(0)
    v_mfma_f32_16x16x32_bf16 v[16:19], v[56:59], a[56:59], v[16:19]
    v_add_f32 v31, 0x3727c5ac, v31
    v_mfma_f32_16x16x32_bf16 v[16:19], v[60:63], a[60:63], v[16:19]
    v_rsq_f32 v31, v31
    s_nop 6
    v_fma_f32 v16, -v30, v17, v16
    v_mul_f32 v16, v16, v31
    s_nop 1
    v_mov_b32_dpp v18, v16 quad_perm:[1,0,3,2] row_mask:0xf bank_mask:0xf
    s_mov_b64 exec, 0x5555
    v_cvt_pk_bf16_f32 v18, v16, v18
    v_min_u32 v18, -2, v18
    s_cmp_eq_u32 s57, 0
    s_cbranch_scc1 Lst_sc1_46
    buffer_store_dword v18, v15, s[48:51], s4 offen
Lst_done_47:
    s_mov_b64 exec, -1
    s_cmp_eq_u32 s35, 0
    s_cbranch_scc1 Lb1_48
    s_barrier
Lb1_48:
    s_cmp_lg_u32 s35, 0
    s_cbranch_scc1 Lw1_49
    s_cmp_lg_u32 s32, 0
    s_cbranch_scc1 Lnoq_50
    v_lshlrev_b32 v20, 7, v0
    s_lshl_b32 s58, s31, 13
    s_add_u32 s58, s58, 0x1000
    s_mov_b32 s56, 0
Lrdy_51:
    buffer_load_dwordx2 v[16:17], v20, s[48:51], s58 offen sc1
    s_waitcnt vmcnt(0)
    v_cmp_ne_u32 vcc, s34, v16
    s_cbranch_vccz Lrdyok_52
    s_add_u32 s56, s56, 1
    s_cmp_lt_u32 s56, 0x61a80
    s_cbranch_scc1 Lrdy_51
    s_branch L_abort
Lrdyok_52:
    v_cmp_eq_u32 vcc, s33, v17
    s_lshl_b32 s59, s29, 3
    s_nop 1
    s_lshr_b64 s[98:99], vcc, s59
    s_and_b32 s98, s98, 0xff
    s_cmp_eq_u32 s98, 0xff
    s_cselect_b32 s57, 1, 0
    v_lshlrev_b32 v20, 4, v0
    s_lshl_b32 s58, s63, 10
    s_add_u32 s58, s58, 0x10000
    s_mov_b32 s56, 0
Lpoll_q0_53:
    buffer_load_dwordx4 v[16:19], v20, s[48:51], s58 offen sc1
    s_waitcnt vmcnt(0)
    v_max3_u32 v21, v16, v17, v18
    v_max_u32 v21, v21, v19
    v_cmp_eq_u32 vcc, -1, v21
    s_cbranch_vccnz Lretry_q0_54
    v_add_u32 v20, 0x21000, v20
    ds_write_b128 v20, v[16:19]
    s_lshl_b32 s58, s57, 1
    s_add_u32 s58, s58, 1
    v_mov_b32 v21, s58
    v_mov_b32 v22, 0x27c70
    s_mov_b64 exec, 1
    ds_write_b32 v22, v21
    s_mov_b64 exec, -1
Lnoq_50:
    s_setprio 1
    s_lshl_b32 s58, s29, 19
    s_lshl_b32 s59, s30, 7
    s_add_u32 s58, s58, s59
    s_add_u32 s36, s12, s58
    s_addc_u32 s37, s13, 0
    s_mov_b32 s38, 0x7fc80
    s_mov_b32 s39, 0x20000
    v_lshrrev_b32 v21, 3, v0
    v_and_b32 v22, 7, v0
    v_and_b32 v23, 1, v2
    v_lshlrev_b32 v23, 1, v23
    v_xor_b32 v22, v22, v23
    v_lshlrev_b32 v22, 4, v22
    v_lshl_add_u32 v23, v21, 10, v22
    v_xor_b32 v24, 64, v23
    s_add_u32 s60, s29, s32
    s_lshl_b32 s61, s97, 1
    s_add_u32 s60, s60, s61
    s_lshl_b32 s60, s60, 1
    s_mul_i32 s58, s29, 448
    s_lshl_b32 s59, s30, 6
    s_add_u32 s58, s58, s59
    s_cmp_ge_u32 s32, 2
    s_cselect_b32 s98, s18, s16
    s_cselect_b32 s99, s19, s17
    s_add_u32 s40, s98, s58
    s_addc_u32 s41, s99, 0
    s_mov_b32 s42, 0x1bf240
    s_mov_b32 s43, 0x20000
    s_and_b32 s61, s32, 1
    s_lshl_b32 s61, s61, 6
    s_lshl_b32 s100, s31, 7
    s_add_u32 s61, s61, s100
    s_mul_i32 s61, s61, 3584
    v_mul_u32_u24 v25, 0xe00, v0
    s_mov_b32 s56, 0
Lfw_wqr_56:
    ds_read_b128 v[16:19], v7 offset:16
    s_waitcnt lgkmcnt(0)
    v_min3_u32 v16, v16, v17, v18
    v_min_u32 v16, v16, v19
    v_cmp_le_u32 vcc, 1, v16
    s_cbranch_vccnz Lfd_wqr_57
    s_add_u32 s56, s56, 1
    s_cmp_lt_u32 s56, 0x61a80
    s_cbranch_scc1 Lfw_wqr_56
    s_branch L_abort
Lfd_wqr_57:
    s_mov_b32 s56, 0
Lfw_vi_58:
    ds_read_b128 v[16:19], v7 offset:240
    s_waitcnt lgkmcnt(0)
    v_min3_u32 v16, v16, v17, v18
    v_min_u32 v16, v16, v19
    v_cmp_le_u32 vcc, 1, v16
    s_cbranch_vccnz Lfd_vi_59
    s_add_u32 s56, s56, 1
    s_cmp_lt_u32 s56, 0x61a80
    s_cbranch_scc1 Lfw_vi_58
    s_branch L_abort
Lfd_vi_59:
    s_mov_b32 s100, s61
    s_add_u32 s61, s60, 0
    s_and_b32 s61, s61, 15
    s_lshl_b32 s99, s32, 4
    s_add_u32 s99, s99, s61
    s_lshl_b32 s98, s99, 10
    s_mov_b32 m0, s98
    s_lshl_b32 s99, s99, 13
    buffer_load_dwordx4 v23, s[36:39], s99 offen lds
    s_add_u32 s61, s60, 1
    s_and_b32 s61, s61, 15
    s_lshl_b32 s99, s32, 4
    s_add_u32 s99, s99, s61
    s_lshl_b32 s98, s99, 10
    s_mov_b32 m0, s98
    s_lshl_b32 s99, s99, 13
    buffer_load_dwordx4 v24, s[36:39], s99 offen lds
    s_add_u32 s61, s60, 2
    s_and_b32 s61, s61, 15
    s_lshl_b32 s99, s32, 4
    s_add_u32 s99, s99, s61
    s_lshl_b32 s98, s99, 10
    s_mov_b32 m0, s98
    s_lshl_b32 s99, s99, 13
    buffer_load_dwordx4 v23, s[36:39], s99 offen lds
    s_add_u32 s61, s60, 3
    s_and_b32 s61, s61, 15
    s_lshl_b32 s99, s32, 4
    s_add_u32 s99, s99, s61
    s_lshl_b32 s98, s99, 10
    s_mov_b32 m0, s98
    s_lshl_b32 s99, s99, 13
    buffer_load_dwordx4 v24, s[36:39], s99 offen lds
    s_add_u32 s61, s60, 4
    s_and_b32 s61, s61, 15
    s_lshl_b32 s99, s32, 4
    s_add_u32 s99, s99, s61
    s_lshl_b32 s98, s99, 10
    s_mov_b32 m0, s98
    s_lshl_b32 s99, s99, 13
    buffer_load_dwordx4 v23, s[36:39], s99 offen lds
    s_add_u32 s61, s60, 5
    s_and_b32 s61, s61, 15
    s_lshl_b32 s99, s32, 4
    s_add_u32 s99, s99, s61
    s_lshl_b32 s98, s99, 10
    s_mov_b32 m0, s98
    s_lshl_b32 s99, s99, 13
    buffer_load_dwordx4 v24, s[36:39], s99 offen lds
    s_add_u32 s61, s60, 6
    s_and_b32 s61, s61, 15
    s_lshl_b32 s99, s32, 4
    s_add_u32 s99, s99, s61
    s_lshl_b32 s98, s99, 10
    s_mov_b32 m0, s98
    s_lshl_b32 s99, s99, 13
    buffer_load_dwordx4 v23, s[36:39], s99 offen lds
    s_add_u32 s61, s60, 7
    s_and_b32 s61, s61, 15
    s_lshl_b32 s99, s32, 4
    s_add_u32 s99, s99, s61
    s_lshl_b32 s98, s99, 10
    s_mov_b32 m0, s98
    s_lshl_b32 s99, s99, 13
    buffer_load_dwordx4 v24, s[36:39], s99 offen lds
    s_add_u32 s61, s60, 8
    s_and_b32 s61, s61, 15
    s_lshl_b32 s99, s32, 4
    s_add_u32 s99, s99, s61
    s_lshl_b32 s98, s99, 10
    s_mov_b32 m0, s98
    s_lshl_b32 s99, s99, 13
    buffer_load_dwordx4 v23, s[36:39], s99 offen lds
    s_add_u32 s61, s60, 9
    s_and_b32 s61, s61, 15
    s_lshl_b32 s99, s32, 4
    s_add_u32 s99, s99, s61
    s_lshl_b32 s98, s99, 10
    s_mov_b32 m0, s98
    s_lshl_b32 s99, s99, 13
    buffer_load_dwordx4 v24, s[36:39], s99 offen lds
    s_add_u32 s61, s60, 10
    s_and_b32 s61, s61, 15
    s_lshl_b32 s99, s32, 4
    s_add_u32 s99, s99, s61
    s_lshl_b32 s98, s99, 10
    s_mov_b32 m0, s98
    s_lshl_b32 s99, s99, 13
    buffer_load_dwordx4 v23, s[36:39], s99 offen lds
    s_add_u32 s61, s60, 11
    s_and_b32 s61, s61, 15
    s_lshl_b32 s99, s32, 4
    s_add_u32 s99, s99, s61
    s_lshl_b32 s98, s99, 10
    s_mov_b32 m0, s98
    s_lshl_b32 s99, s99, 13
    buffer_load_dwordx4 v24, s[36:39], s99 offen lds
    s_add_u32 s61, s60, 12
    s_and_b32 s61, s61, 15
    s_lshl_b32 s99, s32, 4
    s_add_u32 s99, s99, s61
    s_lshl_b32 s98, s99, 10
    s_mov_b32 m0, s98
    s_lshl_b32 s99, s99, 13
    buffer_load_dwordx4 v23, s[36:39], s99 offen lds
    s_add_u32 s61, s60, 13
    s_and_b32 s61, s61, 15
    s_lshl_b32 s99, s32, 4
    s_add_u32 s99, s99, s61
    s_lshl_b32 s98, s99, 10
    s_mov_b32 m0, s98
    s_lshl_b32 s99, s99, 13
    buffer_load_dwordx4 v24, s[36:39], s99 offen lds
    s_add_u32 s61, s60, 14
    s_and_b32 s61, s61, 15
    s_lshl_b32 s99, s32, 4
    s_add_u32 s99, s99, s61
    s_lshl_b32 s98, s99, 10
    s_mov_b32 m0, s98
    s_lshl_b32 s99, s99, 13
    buffer_load_dwordx4 v23, s[36:39], s99 offen lds
    s_add_u32 s61, s60, 15
    s_and_b32 s61, s61, 15
    s_lshl_b32 s99, s32, 4
    s_add_u32 s99, s99, s61
    s_lshl_b32 s98, s99, 10
    s_mov_b32 m0, s98
    s_lshl_b32 s99, s99, 13
    buffer_load_dwordx4 v24, s[36:39], s99 offen lds
    s_cmp_eq_u32 s30, 7
    s_cselect_b32 s42, 0, s42
    buffer_load_dword v26, v25, s[40:43], s100 offen
    s_setprio 3
    s_lshl_b32 s58, s32, 14
    v_xor_b32 v20, 0, v12
    v_lshl_add_u32 v20, v20, 5, v11
    v_add_u32 v20, s58, v20
    v_xor_b32 v21, 1, v12
    v_lshl_add_u32 v21, v21, 5, v11
    v_add_u32 v21, s58, v21
    v_xor_b32 v22, 2, v12
    v_lshl_add_u32 v22, v22, 5, v11
    v_add_u32 v22, s58, v22
    v_xor_b32 v23, 3, v12
    v_lshl_add_u32 v23, v23, 5, v11
    v_add_u32 v23, s58, v23
    s_waitcnt vmcnt(1)
    ds_read_b64_tr_b16 a[64:65], v20 offset:0
    ds_read_b64_tr_b16 a[66:67], v20 offset:512
    ds_read_b64_tr_b16 a[68:69], v20 offset:4096
    ds_read_b64_tr_b16 a[70:71], v20 offset:4608
    ds_read_b64_tr_b16 a[72:73], v20 offset:8192
    ds_read_b64_tr_b16 a[74:75], v20 offset:8704
    ds_read_b64_tr_b16 a[76:77], v20 offset:12288
    ds_read_b64_tr_b16 a[78:79], v20 offset:12800
    ds_read_b64_tr_b16 a[80:81], v21 offset:0
    ds_read_b64_tr_b16 a[82:83], v21 offset:512
    ds_read_b64_tr_b16 a[84:85], v21 offset:4096
    ds_read_b64_tr_b16 a[86:87], v21 offset:4608
    ds_read_b64_tr_b16 a[88:89], v21 offset:8192
    ds_read_b64_tr_b16 a[90:91], v21 offset:8704
    ds_read_b64_tr_b16 a[92:93], v21 offset:12288
    ds_read_b64_tr_b16 a[94:95], v21 offset:12800
    ds_read_b64_tr_b16 a[96:97], v22 offset:0
    ds_read_b64_tr_b16 a[98:99], v22 offset:512
    ds_read_b64_tr_b16 a[100:101], v22 offset:4096
    ds_read_b64_tr_b16 a[102:103], v22 offset:4608
    ds_read_b64_tr_b16 a[104:105], v22 offset:8192
    ds_read_b64_tr_b16 a[106:107], v22 offset:8704
    ds_read_b64_tr_b16 a[108:109], v22 offset:12288
    ds_read_b64_tr_b16 a[110:111], v22 offset:12800
    ds_read_b64_tr_b16 a[112:113], v23 offset:0
    ds_read_b64_tr_b16 a[114:115], v23 offset:512
    ds_read_b64_tr_b16 a[116:117], v23 offset:4096
    ds_read_b64_tr_b16 a[118:119], v23 offset:4608
    ds_read_b64_tr_b16 a[120:121], v23 offset:8192
    ds_read_b64_tr_b16 a[122:123], v23 offset:8704
    ds_read_b64_tr_b16 a[124:125], v23 offset:12288
    ds_read_b64_tr_b16 a[126:127], v23 offset:12800
    v_and_b32 v11, 7, v0
    v_lshlrev_b32 v11, 4, v11
    v_lshl_add_u32 v11, v2, 7, v11
    v_and_b32 v12, 1, v2
    v_lshlrev_b32 v12, 4, v12
    s_mov_b32 s56, 0
Lfw_qbw_60:
    ds_read_b32 v16, v7 offset:48
    s_waitcnt lgkmcnt(0)
    v_cmp_le_u32 vcc, 1, v16
    s_cbranch_vccnz Lfd_qbw_61
    s_add_u32 s56, s56, 1
    s_cmp_lt_u32 s56, 0x61a80
    s_cbranch_scc1 Lfw_qbw_60
    s_branch L_abort
Lfd_qbw_61:
    v_readfirstlane_b32 s58, v16
    s_nop 3
    s_lshr_b32 s57, s58, 1
Lw1_49:
    s_cmp_eq_u32 s35, 0
    s_cbranch_scc1 Lb1_62
    s_barrier
Lb1_62:
    s_cmp_eq_u32 s35, 0
    s_cbranch_scc1 Lg0_op_63
    s_barrier
Lgd_op_64:
    s_mov_b32 s56, 0
Lpoll_o_67:
    buffer_load_dwordx4 v[32:35], v11, s[48:51], s5 offen offset:0 sc1
    buffer_load_dwordx4 v[36:39], v11, s[48:51], s5 offen offset:512 sc1
    buffer_load_dwordx4 v[40:43], v11, s[48:51], s5 offen offset:1024 sc1
    buffer_load_dwordx4 v[44:47], v11, s[48:51], s5 offen offset:1536 sc1
    buffer_load_dwordx4 v[48:51], v12, s[48:51], s6 offen sc1
    buffer_load_dwordx4 v[52:55], v12, s[48:51], s6 offen offset:32 sc1
    s_waitcnt vmcnt(0)
    v_max3_u32 v22, v32, v33, v34
    v_max3_u32 v22, v22, v35, v36
    v_max3_u32 v22, v22, v37, v38
    v_max3_u32 v22, v22, v39, v40
    v_max3_u32 v22, v22, v41, v42
    v_max3_u32 v22, v22, v43, v44
    v_max3_u32 v22, v22, v45, v46
    v_max3_u32 v22, v22, v47, v48
    v_max3_u32 v22, v22, v49, v50
    v_max3_u32 v22, v22, v51, v52
    v_max3_u32 v22, v22, v53, v54
    v_max_u32 v22, v22, v55
    v_cmp_eq_u32 vcc, -1, v22
    s_cbranch_vccnz Lretry_o_68
    v_mfma_f32_16x16x32_bf16 v[16:19], v[32:35], a[64:67], 0
    v_max3_f32 v22, v48, v49, v50
    v_max_f32 v22, v22, v51
    v_mfma_f32_16x16x32_bf16 v[28:31], v[32:35], a[80:83], 0
    v_mov_b32 v23, v22
    v_mfma_f32_16x16x32_bf16 v[56:59], v[32:35], a[96:99], 0
    s_nop 0
    v_mfma_f32_16x16x32_bf16 v[60:63], v[32:35], a[112:115], 0
    v_permlane16_swap_b32 v23, v22
    v_max_f32 v22, v22, v23
    v_mfma_f32_16x16x32_bf16 v[16:19], v[36:39], a[68:71], v[16:19]
    v_sub_f32 v48, v48, v22
    v_sub_f32 v49, v49, v22
    v_mfma_f32_16x16x32_bf16 v[28:31], v[36:39], a[84:87], v[28:31]
    v_sub_f32 v50, v50, v22
    v_sub_f32 v51, v51, v22
    v_mfma_f32_16x16x32_bf16 v[56:59], v[36:39], a[100:103], v[56:59]
    v_exp_f32 v48, v48
    v_exp_f32 v49, v49
    v_mfma_f32_16x16x32_bf16 v[60:63], v[36:39], a[116:119], v[60:63]
    v_exp_f32 v50, v50
    v_exp_f32 v51, v51
    v_mfma_f32_16x16x32_bf16 v[16:19], v[40:43], a[72:75], v[16:19]
    v_mul_f32 v23, v48, v52
    v_fma_f32 v23, v49, v53, v23
    v_mfma_f32_16x16x32_bf16 v[28:31], v[40:43], a[88:91], v[28:31]
    v_fma_f32 v23, v50, v54, v23
    v_fma_f32 v23, v51, v55, v23
    v_mfma_f32_16x16x32_bf16 v[56:59], v[40:43], a[104:107], v[56:59]
    v_mov_b32 v24, v23
    v_mfma_f32_16x16x32_bf16 v[60:63], v[40:43], a[120:123], v[60:63]
    s_nop 0
    v_mfma_f32_16x16x32_bf16 v[16:19], v[44:47], a[76:79], v[16:19]
    v_permlane16_swap_b32 v24, v23
    v_add_f32 v23, v23, v24
    v_mfma_f32_16x16x32_bf16 v[28:31], v[44:47], a[92:95], v[28:31]
    v_rcp_f32 v23, v23
    v_mfma_f32_16x16x32_bf16 v[56:59], v[44:47], a[108:111], v[56:59]
    v_mul_f32 v48, v48, v23
    v_mul_f32 v49, v49, v23
    v_mfma_f32_16x16x32_bf16 v[60:63], v[44:47], a[124:127], v[60:63]
    v_mul_f32 v50, v50, v23
    v_mul_f32 v51, v51, v23
    s_mov_b32 s98, 0
    s_mov_b32 s99, -1
    s_add_u32 s58, s35, 1
    s_nop 2
    v_mul_f32 v16, v16, v48
    v_fma_f32 v16, v17, v49, v16
    v_mul_f32 v28, v28, v48
    v_fma_f32 v28, v29, v49, v28
    v_mul_f32 v56, v56, v48
    v_fma_f32 v56, v57, v49, v56
    v_mul_f32 v60, v60, v48
    v_fma_f32 v60, v61, v49, v60
    v_fma_f32 v16, v18, v50, v16
    v_fma_f32 v28, v30, v50, v28
    v_fma_f32 v56, v58, v50, v56
    v_fma_f32 v60, v62, v50, v60
    v_fma_f32 v16, v19, v51, v16
    v_fma_f32 v28, v31, v51, v28
    v_fma_f32 v56, v59, v51, v56
    v_fma_f32 v60, v63, v51, v60
    s_nop 0
    v_permlane16_swap_b32 v16, v28
    v_permlane16_swap_b32 v56, v60
    v_add_f32 v16, v16, v28
    v_add_f32 v56, v56, v60
    v_cndmask_b32 v16, v16, v56, s[98:99]
    ds_write_b32 v13, v16
    s_cmp_eq_u32 s35, 0
    s_cbranch_scc1 Lg0_red_70
    s_waitcnt lgkmcnt(0)
    s_barrier
Lgd_red_71:
    s_cmp_lg_u32 s32, 0
    s_cbranch_scc1 Lnopub_69
    v_lshlrev_b32 v20, 5, v0
    v_and_b32 v20, 0x3ff, v20
    v_add_u32 v20, 0x27840, v20
    ds_read_b128 v[16:19], v20
    ds_read_b128 v[24:27], v20 offset:16
    v_lshlrev_b32 v21, 2, v0
    s_waitcnt lgkmcnt(0)
    v_add_f32 v16, v16, v17
    v_add_f32 v24, v24, v25
    v_add_f32 v18, v18, v19
    v_add_f32 v26, v26, v27
    v_add_f32 v16, v16, v18
    v_add_f32 v24, v24, v26
    s_mov_b32 exec_lo, -1
    s_mov_b32 exec_hi, 0
    v_cvt_pk_bf16_f32 v16, v16, v24
    v_min_u32 v16, -2, v16
    buffer_store_dword v16, v21, s[48:51], s7 offen sc1
    s_mov_b64 exec, -1
    s_waitcnt vmcnt(0)
    s_cmp_lg_u32 s35, 0
    s_cbranch_scc1 Lx3f_75
    v_mov_b32 v21, 1
    s_mov_b64 exec, 1
    ds_write_b32 v6, v21 offset:176
    s_mov_b64 exec, -1
Lx3f_75:
Lnopub_69:
    s_cmp_eq_u32 s35, 0
    s_cbranch_scc1 Lg0_x3p_76
    s_barrier
Lgd_x3p_77:
    s_mov_b32 s100, 0x3f80
    s_mov_b32 s101, 0x3f800000
    s_mov_b32 s56, 0
Lpoll_x3_80:
    buffer_load_dwordx4 v[32:35], v9, s[48:51], s8 offen sc1
    buffer_load_dwordx4 v[36:39], v9, s[48:51], s9 offen sc1
    s_waitcnt vmcnt(0)
    v_max3_u32 v22, v32, v33, v34
    v_max3_u32 v22, v22, v35, v36
    v_max3_u32 v22, v22, v37, v38
    v_max_u32 v22, v22, v39
    v_cmp_eq_u32 vcc, -1, v22
    s_cbranch_vccnz Lretry_x3_81
    v_dot2_f32_bf16 v40, v32, s100, 0
    v_dot2_f32_bf16 v41, v32, s101, 0
    v_dot2_f32_bf16 v42, v33, s100, 0
    v_dot2_f32_bf16 v43, v33, s101, 0
    v_dot2_f32_bf16 v44, v34, s100, 0
    v_dot2_f32_bf16 v45, v34, s101, 0
    v_dot2_f32_bf16 v46, v35, s100, 0
    v_dot2_f32_bf16 v47, v35, s101, 0
    v_dot2_f32_bf16 v40, v36, s100, v40
    v_dot2_f32_bf16 v41, v36, s101, v41
    v_dot2_f32_bf16 v42, v37, s100, v42
    v_dot2_f32_bf16 v43, v37, s101, v43
    v_dot2_f32_bf16 v44, v38, s100, v44
    v_dot2_f32_bf16 v45, v38, s101, v45
    v_dot2_f32_bf16 v46, v39, s100, v46
    v_dot2_f32_bf16 v47, v39, s101, v47
    s_nop 0
    v_permlane32_swap_b32 v40, v44
    v_permlane32_swap_b32 v41, v45
    v_permlane32_swap_b32 v42, v46
    v_permlane32_swap_b32 v43, v47
    v_pk_add_f32 v[40:41], v[40:41], v[44:45]
    v_pk_add_f32 v[42:43], v[42:43], v[46:47]
    s_nop 1
    v_permlane16_swap_b32 v40, v42
    v_permlane16_swap_b32 v41, v43
    v_pk_add_f32 v[40:41], v[40:41], v[42:43]
    v_pk_add_f32 v[40:41], v[40:41], v[4:5]
    v_cvt_pk_bf16_f32 v22, v40, v41
    ds_write_b32 v3, v22
    v_lshlrev_b32 v4, 16, v22
    v_and_b32 v5, 0xffff0000, v22
    s_cmp_eq_u32 s35, 0
    s_cbranch_scc1 Lg0_xg_83
    s_waitcnt lgkmcnt(0)
    s_barrier
Lgd_xg_84:
    s_cmp_eq_u32 s30, 7
    s_cbranch_scc1 Lnog_82
    ds_read_b128 v[24:27], v14
    ds_read_b128 v[32:35], v8 offset:0
    ds_read_b128 v[36:39], v8 offset:64
    ds_read_b128 v[40:43], v8 offset:128
    ds_read_b128 v[44:47], v8 offset:192
    ds_read_b128 v[48:51], v8 offset:256
    ds_read_b128 v[52:55], v8 offset:320
    ds_read_b128 v[56:59], v8 offset:384
    ds_read_b128 v[60:63], v8 offset:448
    s_mov_b32 s100, 0x3f803f80
    v_mov_b32 v21, 0x3b000000
    s_waitcnt lgkmcnt(6)
    v_mfma_f32_16x16x32_bf16 v[16:19], v[32:35], v[64:67], 0
    ds_read_b128 v[32:35], v8 offset:512
    v_dot2_f32_bf16 v28, v24, s100, 0
    v_dot2_f32_bf16 v29, v24, v24, 0
    v_mfma_f32_16x16x32_bf16 v[16:19], v[36:39], v[68:71], v[16:19]
    ds_read_b128 v[36:39], v8 offset:576
    v_dot2_f32_bf16 v28, v25, s100, v28
    v_dot2_f32_bf16 v29, v25, v25, v29
    s_waitcnt lgkmcnt(6)
    v_mfma_f32_16x16x32_bf16 v[16:19], v[40:43], v[72:75], v[16:19]
    ds_read_b128 v[40:43], v8 offset:640
    v_dot2_f32_bf16 v28, v26, s100, v28
    v_dot2_f32_bf16 v29, v26, v26, v29
    v_mfma_f32_16x16x32_bf16 v[16:19], v[44:47], v[76:79], v[16:19]
    ds_read_b128 v[44:47], v8 offset:704
    v_dot2_f32_bf16 v28, v27, s100, v28
    v_dot2_f32_bf16 v29, v27, v27, v29
    s_waitcnt lgkmcnt(6)
    v_mfma_f32_16x16x32_bf16 v[16:19], v[48:51], v[80:83], v[16:19]
    ds_read_b128 v[48:51], v8 offset:768
    v_add_f32_dpp v28, v28, v28 row_shr:1 row_mask:0xf bank_mask:0xf bound_ctrl:0
    v_add_f32_dpp v29, v29, v29 row_shr:1 row_mask:0xf bank_mask:0xf bound_ctrl:0
    v_mfma_f32_16x16x32_bf16 v[16:19], v[52:55], v[84:87], v[16:19]
    ds_read_b128 v[52:55], v8 offset:832
    v_add_f32_dpp v28, v28, v28 row_shr:2 row_mask:0xf bank_mask:0xf bound_ctrl:0
    v_add_f32_dpp v29, v29, v29 row_shr:2 row_mask:0xf bank_mask:0xf bound_ctrl:0
    s_waitcnt lgkmcnt(6)
    v_mfma_f32_16x16x32_bf16 v[16:19], v[56:59], v[88:91], v[16:19]
    ds_read_b128 v[56:59], v8 offset:896
    v_add_f32_dpp v28, v28, v28 row_shr:4 row_mask:0xf bank_mask:0xf bound_ctrl:0
    v_add_f32_dpp v29, v29, v29 row_shr:4 row_mask:0xf bank_mask:0xf bound_ctrl:0
    v_mfma_f32_16x16x32_bf16 v[16:19], v[60:63], v[92:95], v[16:19]
    ds_read_b128 v[60:63], v8 offset:960
    v_add_f32_dpp v28, v28, v28 row_shr:8 row_mask:0xf bank_mask:0xf bound_ctrl:0
    v_add_f32_dpp v29, v29, v29 row_shr:8 row_mask:0xf bank_mask:0xf bound_ctrl:0
    s_waitcnt lgkmcnt(6)
    v_mfma_f32_16x16x32_bf16 v[16:19], v[32:35], v[96:99], v[16:19]
    v_add_f32_dpp v28, v28, v28 row_bcast:15 row_mask:0xa bank_mask:0xf
    v_add_f32_dpp v29, v29, v29 row_bcast:15 row_mask:0xa bank_mask:0xf
    v_mfma_f32_16x16x32_bf16 v[16:19], v[36:39], v[100:103], v[16:19]
    v_add_f32_dpp v28, v28, v28 row_bcast:31 row_mask:0xc bank_mask:0xf
    v_add_f32_dpp v29, v29, v29 row_bcast:31 row_mask:0xc bank_mask:0xf
    s_waitcnt lgkmcnt(4)
    v_mfma_f32_16x16x32_bf16 v[16:19], v[40:43], v[104:107], v[16:19]
    s_nop 0
    v_readlane_b32 s60, v28, 63
    v_readlane_b32 s61, v29, 63
    v_mfma_f32_16x16x32_bf16 v[16:19], v[44:47], v[108:111], v[16:19]
    v_mul_f32 v30, s60, v21
    v_mul_f32 v31, s61, v21
    s_waitcnt lgkmcnt(2)
    v_mfma_f32_16x16x32_bf16 v[16:19], v[48:51], v[112:115], v[16:19]
    v_fma_f32 v31, -v30, v30, v31
    v_mfma_f32_16x16x32_bf16 v[16:19], v[52:55], v[116:119], v[16:19]
    v_max_f32 v31, 0, v31
    s_waitcnt lgkmcnt(0)
    v_mfma_f32_16x16x32_bf16 v[16:19], v[56:59], v[120:123], v[16:19]
    v_add_f32 v31, 0x3727c5ac, v31
    v_mfma_f32_16x16x32_bf16 v[16:19], v[60:63], v[124:127], v[16:19]
    v_rsq_f32 v31, v31
    s_nop 6
    v_fma_f32 v16, -v30, v17, v16
    v_mul_f32 v16, v16, v31
    s_nop 1
    v_mov_b32_dpp v17, v16 row_shl:8 row_mask:0xf bank_mask:0xf
    v_mul_f32 v16, 0xbfb8aa3b, v16
    v_exp_f32 v16, v16
    s_nop 0
    v_add_f32 v16, 1.0, v16
    v_rcp_f32 v16, v16
    s_nop 0
    v_mul_f32 v16, v16, v17
    s_nop 1
    v_mov_b32_dpp v18, v16 quad_perm:[1,0,3,2] row_mask:0xf bank_mask:0xf
    s_mov_b64 exec, 0x55
    v_cvt_pk_bf16_f32 v18, v16, v18
    v_min_u32 v18, -2, v18
    s_cmp_eq_u32 s57, 0
    s_cbranch_scc1 Lst_sc1_90
    buffer_store_dword v18, v10, s[48:51], s10 offen
Lst_done_91:
    s_mov_b64 exec, -1
Lnog_82:
    s_barrier
    s_cmp_lg_u32 s35, 0
    s_cbranch_scc1 Llast_92
    s_add_u32 s4, s4, 0x80000
    s_add_u32 s5, s5, 0x80000
    s_add_u32 s6, s6, 0x80000
    s_add_u32 s7, s7, 0x80000
    s_add_u32 s8, s8, 0x80000
    s_add_u32 s9, s9, 0x80000
    s_add_u32 s10, s10, 0x80000
    s_barrier
    s_barrier
    s_mov_b32 s100, 0x3f80
    s_mov_b32 s101, 0x3f800000
    s_mov_b32 s56, 0
Lpoll_x5_93:
    buffer_load_dwordx4 v[32:35], v9, s[48:51], s11 offen sc1
    buffer_load_dwordx4 v[36:39], v9, s[48:51], s14 offen sc1
    s_waitcnt vmcnt(0)
    v_max3_u32 v22, v32, v33, v34
    v_max3_u32 v22, v22, v35, v36
    v_max3_u32 v22, v22, v37, v38
    v_max_u32 v22, v22, v39
    v_cmp_eq_u32 vcc, -1, v22
    s_cbranch_vccnz Lretry_x5_94
    v_dot2_f32_bf16 v40, v32, s100, 0
    v_dot2_f32_bf16 v41, v32, s101, 0
    v_dot2_f32_bf16 v42, v33, s100, 0
    v_dot2_f32_bf16 v43, v33, s101, 0
    v_dot2_f32_bf16 v44, v34, s100, 0
    v_dot2_f32_bf16 v45, v34, s101, 0
    v_dot2_f32_bf16 v46, v35, s100, 0
    v_dot2_f32_bf16 v47, v35, s101, 0
    v_dot2_f32_bf16 v40, v36, s100, v40
    v_dot2_f32_bf16 v41, v36, s101, v41
    v_dot2_f32_bf16 v42, v37, s100, v42
    v_dot2_f32_bf16 v43, v37, s101, v43
    v_dot2_f32_bf16 v44, v38, s100, v44
    v_dot2_f32_bf16 v45, v38, s101, v45
    v_dot2_f32_bf16 v46, v39, s100, v46
    v_dot2_f32_bf16 v47, v39, s101, v47
    s_nop 0
    v_permlane32_swap_b32 v40, v44
    v_permlane32_swap_b32 v41, v45
    v_permlane32_swap_b32 v42, v46
    v_permlane32_swap_b32 v43, v47
    v_pk_add_f32 v[40:41], v[40:41], v[44:45]
    v_pk_add_f32 v[42:43], v[42:43], v[46:47]
    s_nop 1
    v_permlane16_swap_b32 v40, v42
    v_permlane16_swap_b32 v41, v43
    v_pk_add_f32 v[40:41], v[40:41], v[42:43]
    v_pk_add_f32 v[40:41], v[40:41], v[4:5]
    v_cvt_pk_bf16_f32 v22, v40, v41
    ds_write_b32 v3, v22
    v_lshlrev_b32 v4, 16, v22
    v_and_b32 v5, 0xffff0000, v22
    s_mov_b32 s35, 1
    s_add_u32 s11, s11, 0x80000
    s_add_u32 s14, s14, 0x80000
    s_waitcnt lgkmcnt(0)
    s_barrier
    s_branch L_W_loop
Llast_92:
    s_lshl_b32 s58, s31, 10
    s_add_u32 s52, s22, s58
    s_addc_u32 s53, s23, 0
    s_mov_b32 s54, 0x400
    s_mov_b32 s55, 0x20000
    v_subrev_u32 v20, 0x27000, v3
    s_barrier
    s_add_u32 s58, s29, s30
    s_cmp_lg_u32 s58, 0
    s_cbranch_scc1 L_fin
    s_barrier
    s_mov_b32 s100, 0x3f80
    s_mov_b32 s101, 0x3f800000
    s_mov_b32 s56, 0
Lpoll_x5f_95:
    buffer_load_dwordx4 v[32:35], v9, s[48:51], s11 offen sc1
    buffer_load_dwordx4 v[36:39], v9, s[48:51], s14 offen sc1
    s_waitcnt vmcnt(0)
    v_max3_u32 v22, v32, v33, v34
    v_max3_u32 v22, v22, v35, v36
    v_max3_u32 v22, v22, v37, v38
    v_max_u32 v22, v22, v39
    v_cmp_eq_u32 vcc, -1, v22
    s_cbranch_vccnz Lretry_x5f_96
    v_dot2_f32_bf16 v40, v32, s100, 0
    v_dot2_f32_bf16 v41, v32, s101, 0
    v_dot2_f32_bf16 v42, v33, s100, 0
    v_dot2_f32_bf16 v43, v33, s101, 0
    v_dot2_f32_bf16 v44, v34, s100, 0
    v_dot2_f32_bf16 v45, v34, s101, 0
    v_dot2_f32_bf16 v46, v35, s100, 0
    v_dot2_f32_bf16 v47, v35, s101, 0
    v_dot2_f32_bf16 v40, v36, s100, v40
    v_dot2_f32_bf16 v41, v36, s101, v41
    v_dot2_f32_bf16 v42, v37, s100, v42
    v_dot2_f32_bf16 v43, v37, s101, v43
    v_dot2_f32_bf16 v44, v38, s100, v44
    v_dot2_f32_bf16 v45, v38, s101, v45
    v_dot2_f32_bf16 v46, v39, s100, v46
    v_dot2_f32_bf16 v47, v39, s101, v47
    s_nop 0
    v_permlane32_swap_b32 v40, v44
    v_permlane32_swap_b32 v41, v45
    v_permlane32_swap_b32 v42, v46
    v_permlane32_swap_b32 v43, v47
    v_pk_add_f32 v[40:41], v[40:41], v[44:45]
    v_pk_add_f32 v[42:43], v[42:43], v[46:47]
    s_nop 1
    v_permlane16_swap_b32 v40, v42
    v_permlane16_swap_b32 v41, v43
    v_pk_add_f32 v[40:41], v[40:41], v[42:43]
    v_pk_add_f32 v[40:41], v[40:41], v[4:5]
    v_cvt_pk_bf16_f32 v22, v40, v41
    buffer_store_dword v22, v20, s[52:55], 0 offen
    s_cmp_lg_u32 s32, 0
    s_cbranch_scc1 L_fin
    s_lshl_b32 s58, s31, 7
    v_mov_b32 v16, s34
    v_mov_b32 v18, 0
    s_mov_b64 exec, 1
    buffer_store_dword v16, v18, s[48:51], s58 offen
    s_branch L_fin
Lretry_q_5:
    s_add_u32 s56, s56, 1
    s_cmp_lt_u32 s56, 0x61a80
    s_cbranch_scc1 Lpoll_q_4
    s_branch L_abort
Lg0_p_6:
    s_waitcnt vmcnt(0)
    v_mov_b32 v58, 1
    s_mov_b64 exec, 1
    ds_write_b32 v3, v58 offset:64
    s_mov_b64 exec, -1
    s_mov_b32 s56, 0
Lfw_p_8:
    ds_read_b128 v[16:19], v4 offset:64
    s_waitcnt lgkmcnt(0)
    v_min3_u32 v16, v16, v17, v18
    v_min_u32 v16, v16, v19
    v_cmp_le_u32 vcc, 1, v16
    s_cbranch_vccnz Lfd_p_9
    s_add_u32 s56, s56, 1
    s_cmp_lt_u32 s56, 0x61a80
    s_cbranch_scc1 Lfw_p_8
    s_branch L_abort
Lfd_p_9:
    s_branch Lgd_p_7
Lst_sc1_12:
    buffer_store_dwordx2 v[26:27], v13, s[48:51], s5 offen sc1
    buffer_store_dwordx2 v[28:29], v13, s[48:51], s5 offen offset:256 sc1
    s_branch Lst_done_13
Lst_sc1_15:
    buffer_store_dword v24, v30, s[48:51], s10 offen sc1
    buffer_store_dword v25, v30, s[48:51], s10 offen offset:32 sc1
    s_branch Lst_done_16
Lg0_op_17:
    v_mov_b32 v30, 1
    s_mov_b64 exec, 1
    ds_write_b32 v3, v30 offset:160
    s_mov_b64 exec, -1
    s_branch Lgd_op_18
Lretry_h_32:
    s_add_u32 s56, s56, 1
    s_cmp_lt_u32 s56, 0x61a80
    s_cbranch_scc1 Lpoll_h_31
    s_branch L_abort
Lst_sc1_46:
    buffer_store_dword v18, v15, s[48:51], s4 offen sc1
    s_branch Lst_done_47
Lretry_q0_54:
    s_add_u32 s56, s56, 1
    s_cmp_lt_u32 s56, 0x61a80
    s_cbranch_scc1 Lpoll_q0_53
    s_branch L_abort
Lg0_op_63:
    s_mov_b32 s56, 0
Lfw_op_65:
    ds_read_b128 v[16:19], v7 offset:160
    s_waitcnt lgkmcnt(0)
    v_min3_u32 v16, v16, v17, v18
    v_min_u32 v16, v16, v19
    v_cmp_le_u32 vcc, 1, v16
    s_cbranch_vccnz Lfd_op_66
    s_add_u32 s56, s56, 1
    s_cmp_lt_u32 s56, 0x61a80
    s_cbranch_scc1 Lfw_op_65
    s_branch L_abort
Lfd_op_66:
    s_branch Lgd_op_64
Lretry_o_68:
    s_add_u32 s56, s56, 1
    s_cmp_lt_u32 s56, 0x61a80
    s_cbranch_scc1 Lpoll_o_67
    s_branch L_abort
Lg0_red_70:
    v_mov_b32 v21, 1
    s_mov_b64 exec, 1
    ds_write_b32 v6, v21 offset:96
    s_mov_b64 exec, -1
    s_cmp_lg_u32 s32, 0
    s_cbranch_scc1 Lr0_72
    s_mov_b32 s56, 0
Lfw_red_73:
    ds_read_b128 v[16:19], v7 offset:96
    s_waitcnt lgkmcnt(0)
    v_min3_u32 v16, v16, v17, v18
    v_min_u32 v16, v16, v19
    v_cmp_le_u32 vcc, 1, v16
    s_cbranch_vccnz Lfd_red_74
    s_add_u32 s56, s56, 1
    s_cmp_lt_u32 s56, 0x61a80
    s_cbranch_scc1 Lfw_red_73
    s_branch L_abort
Lfd_red_74:
Lr0_72:
    s_branch Lgd_red_71
Lg0_x3p_76:
    s_mov_b32 s56, 0
Lfw_x3p_78:
    ds_read_b32 v16, v7 offset:176
    s_waitcnt lgkmcnt(0)
    v_cmp_le_u32 vcc, 1, v16
    s_cbranch_vccnz Lfd_x3p_79
    s_add_u32 s56, s56, 1
    s_cmp_lt_u32 s56, 0x61a80
    s_cbranch_scc1 Lfw_x3p_78
    s_branch L_abort
Lfd_x3p_79:
    s_branch Lgd_x3p_77
Lretry_x3_81:
    s_add_u32 s56, s56, 1
    s_cmp_lt_u32 s56, 0x61a80
    s_cbranch_scc1 Lpoll_x3_80
    s_branch L_abort
Lg0_xg_83:
    v_mov_b32 v21, 2
    s_mov_b64 exec, 1
    ds_write_b32 v6, v21 offset:32
    s_mov_b64 exec, -1
    s_cmp_eq_u32 s96, 1
    s_cbranch_scc1 Lxg7_85
    s_mov_b32 s56, 0
Lfw_gu_86:
    ds_read_b128 v[16:19], v7 offset:112
    s_waitcnt lgkmcnt(0)
    v_min3_u32 v16, v16, v17, v18
    v_min_u32 v16, v16, v19
    v_cmp_le_u32 vcc, 1, v16
    s_cbranch_vccnz Lfd_gu_87
    s_add_u32 s56, s56, 1
    s_cmp_lt_u32 s56, 0x61a80
    s_cbranch_scc1 Lfw_gu_86
    s_branch L_abort
Lfd_gu_87:
    v_lshrrev_b32 v24, 2, v1
    v_and_b32 v25, 3, v0
    v_lshl_add_u32 v24, v2, 3, v24
    v_lshlrev_b32 v24, 6, v24
    v_lshrrev_b32 v26, 1, v25
    v_lshl_add_u32 v24, v26, 15, v24
    v_lshlrev_b32 v26, 1, v26
    v_and_b32 v27, 1, v2
    v_xor_b32 v26, v26, v27
    v_xor_b32 v26, s32, v26
    v_lshl_add_u32 v24, v26, 4, v24
    v_and_b32 v25, 1, v25
    v_lshl_add_u32 v24, v25, 3, v24
    v_add_u32 v24, 0x10000, v24
    ds_read_b64_tr_b16 v[64:65], v24 offset:0
    ds_read_b64_tr_b16 v[66:67], v24 offset:256
    ds_read_b64_tr_b16 v[68:69], v24 offset:2048
    ds_read_b64_tr_b16 v[70:71], v24 offset:2304
    ds_read_b64_tr_b16 v[72:73], v24 offset:4096
    ds_read_b64_tr_b16 v[74:75], v24 offset:4352
    ds_read_b64_tr_b16 v[76:77], v24 offset:6144
    ds_read_b64_tr_b16 v[78:79], v24 offset:6400
    ds_read_b64_tr_b16 v[80:81], v24 offset:8192
    ds_read_b64_tr_b16 v[82:83], v24 offset:8448
    ds_read_b64_tr_b16 v[84:85], v24 offset:10240
    ds_read_b64_tr_b16 v[86:87], v24 offset:10496
    ds_read_b64_tr_b16 v[88:89], v24 offset:12288
    ds_read_b64_tr_b16 v[90:91], v24 offset:12544
    ds_read_b64_tr_b16 v[92:93], v24 offset:14336
    ds_read_b64_tr_b16 v[94:95], v24 offset:14592
    ds_read_b64_tr_b16 v[96:97], v24 offset:16384
    ds_read_b64_tr_b16 v[98:99], v24 offset:16640
    ds_read_b64_tr_b16 v[100:101], v24 offset:18432
    ds_read_b64_tr_b16 v[102:103], v24 offset:18688
    ds_read_b64_tr_b16 v[104:105], v24 offset:20480
    ds_read_b64_tr_b16 v[106:107], v24 offset:20736
    ds_read_b64_tr_b16 v[108:109], v24 offset:22528
    ds_read_b64_tr_b16 v[110:111], v24 offset:22784
    ds_read_b64_tr_b16 v[112:113], v24 offset:24576
    ds_read_b64_tr_b16 v[114:115], v24 offset:24832
    ds_read_b64_tr_b16 v[116:117], v24 offset:26624
    ds_read_b64_tr_b16 v[118:119], v24 offset:26880
    ds_read_b64_tr_b16 v[120:121], v24 offset:28672
    ds_read_b64_tr_b16 v[122:123], v24 offset:28928
    ds_read_b64_tr_b16 v[124:125], v24 offset:30720
    ds_read_b64_tr_b16 v[126:127], v24 offset:30976
    s_mov_b32 s96, 1
Lxg7_85:
    s_mov_b32 s56, 0
Lfw_xbg_88:
    ds_read_b128 v[16:19], v7 offset:32
    s_waitcnt lgkmcnt(0)
    v_min3_u32 v16, v16, v17, v18
    v_min_u32 v16, v16, v19
    v_cmp_le_u32 vcc, 2, v16
    s_cbranch_vccnz Lfd_xbg_89
    s_add_u32 s56, s56, 1
    s_cmp_lt_u32 s56, 0x61a80
    s_cbranch_scc1 Lfw_xbg_88
    s_branch L_abort
Lfd_xbg_89:
    s_branch Lgd_xg_84
Lst_sc1_90:
    buffer_store_dword v18, v10, s[48:51], s10 offen sc1
    s_branch Lst_done_91
Lretry_x5_94:
    s_add_u32 s56, s56, 1
    s_cmp_lt_u32 s56, 0x61a80
    s_cbranch_scc1 Lpoll_x5_93
    s_branch L_abort
Lretry_x5f_96:
    s_add_u32 s56, s56, 1
    s_cmp_lt_u32 s56, 0x61a80
    s_cbranch_scc1 Lpoll_x5f_95
    s_branch L_abort
L_abort:
L_fin:
L_end:
    s_endpgm
.section .rodata,"a"
.p2align 6
.amdhsa_kernel interleave_layers__sliding_block_cached__glu_gated_glu__decode_kernel
  .amdhsa_next_free_vgpr 256
  .amdhsa_next_free_sgpr 102
  .amdhsa_accum_offset 128
  .amdhsa_group_segment_fixed_size 0
  .amdhsa_kernarg_size 96
  .amdhsa_user_sgpr_count 2
  .amdhsa_user_sgpr_kernarg_segment_ptr 1
  .amdhsa_system_sgpr_workgroup_id_x 1
  .amdhsa_float_denorm_mode_32 3
.end_amdhsa_kernel
```
